```python
import torch

def _softmax(x, axis=-1):
    return torch.softmax(x, dim=axis)
def _gelu(x):
    return torch.nn.functional.gelu(x, approximate="tanh")
def _silu(x):
    return torch.nn.functional.silu(x)
def _sigmoid(x):
    return torch.sigmoid(x)
def _layernorm(x, axis=-1, eps=1e-5):
    m = x.mean(dim=axis, keepdim=True)
    v = x.var(dim=axis, keepdim=True, unbiased=False)
    return (x - m) / torch.sqrt(v + eps)
def _scatter_add(tgt, idx, src, axis=0):
    return tgt.clone().index_add_(axis, idx, src)
def _segment_sum(src, seg, n):
    out = torch.zeros((n,) + src.shape[1:], dtype=src.dtype)
    return out.index_add_(0, seg, src)
def _pad(x, pw):
    flat = tuple(v for pair in reversed(pw) for v in pair)
    return torch.nn.functional.pad(x, flat)

kernel_name = 'sequential_preLN__sliding_block__dense_activation_squared_relu__prompt'

def setup_inputs():

    _w = (lambda a: (lambda t: t.to(torch.bfloat16) if t.is_floating_point() else t)(torch.as_tensor(a)))
    def _A_setup():
        B, S, D = 1, 2048, 512
        return {
            "x": _w((lambda *s: torch.randn(*s, dtype=torch.bfloat16) * 0.05)(B, S, D)),
            "wqkv": _w((lambda *s: torch.randn(*s, dtype=torch.bfloat16) * 0.05)(D, 3 * D)),
            "wo": _w((lambda *s: torch.randn(*s, dtype=torch.bfloat16) * 0.05)(D, D)),
        }
    _A_in = _A_setup()

    def _B_setup():
        B, S, D, F = 1, 2048, 512, 1792
        return {
            "x": _w((lambda *s: torch.randn(*s, dtype=torch.bfloat16) * 0.05)(B, S, D)),
            "w1": _w((lambda *s: torch.randn(*s, dtype=torch.bfloat16) * 0.05)(D, F)),
            "b1": _w((lambda *s: torch.randn(*s, dtype=torch.bfloat16) * 0.4)(F)),
            "w2": _w((lambda *s: torch.randn(*s, dtype=torch.bfloat16) * 0.05)(F, D)),
            "b2": _w((lambda *s: torch.randn(*s, dtype=torch.bfloat16) * 1.6)(D)),
        }
    _B_in = _B_setup()

    return {
        "A_x": _A_in["x"],
        "A_wqkv": _A_in["wqkv"],
        "A_wo": _A_in["wo"],
        "B_x": _B_in["x"],
        "B_w1": _B_in["w1"],
        "B_b1": _B_in["b1"],
        "B_w2": _B_in["w2"],
        "B_b2": _B_in["b2"],
    }

def reference(A_x, A_wqkv, A_wo, B_x, B_w1, B_b1, B_w2, B_b2):
    def _A_ref(x, wqkv, wo):
        B, S, D = x.shape
        H = 32; Dh = D // H; W = 256
        qkv = (lambda x, *d: x.permute(*d))((x @ wqkv).reshape(B, S, 3, H, Dh), 2, 0, 3, 1, 4)
        q, k, v = qkv[0], qkv[1], qkv[2]
        scores = torch.einsum("bhqd,bhkd->bhqk", q, k) * (Dh ** -0.5)
        idx = torch.arange(S)
        mask = (idx[:, None] - idx[None, :] >= 0) & (idx[:, None] - idx[None, :] < W)
        scores = torch.where(mask[None, None], scores, -1e9)
        p = _softmax(scores, axis=-1)
        o = torch.einsum("bhqk,bhkd->bhqd", p, v)
        return (lambda x, *d: x.permute(*d))(o, 0, 2, 1, 3).reshape(B, S, D) @ wo

    def _B_ref(x, w1, b1, w2, b2):
        h = torch.einsum("bsd,df->bsf", x, w1) + b1
        zero = torch.zeros_like(h)
        r = torch.where(h > zero, h, zero)
        h = r * r
        out = torch.einsum("bsf,fd->bsd", h, w2) + b2
        return out

    x = A_x
    h = x + _A_ref(_layernorm(x, axis=-1), A_wqkv, A_wo)
    h2 = h + _B_ref(_layernorm(h, axis=-1), B_w1, B_b1, B_w2, B_b2)
    return h2
```

```asm
; @launch grid=(256,1,1) block=(512,1,1) lds=163840
.amdgcn_target "amdgcn-amd-amdhsa--gfx950"
.text
.globl sequential_preLN__sliding_block__dense_activation_squared_relu__prompt_kernel
.p2align 8
.type sequential_preLN__sliding_block__dense_activation_squared_relu__prompt_kernel,@function
sequential_preLN__sliding_block__dense_activation_squared_relu__prompt_kernel:
  s_cmp_ge_u32 s2, 256
  s_cbranch_scc1 L_end
  s_load_dwordx4 s[56:59], s[0:1], 0
  s_load_dwordx2 s[60:61], s[0:1], 16
  s_load_dwordx8 s[64:71], s[0:1], 32
  s_load_dwordx4 s[72:75], s[0:1], 64
  s_load_dwordx2 s[76:77], s[0:1], 80
  v_and_b32 v186, 63, v0
  v_lshrrev_b32 v1, 6, v0
  s_and_b32 s49, s2, 7
  v_readfirstlane_b32 s48, v1
  s_lshr_b32 s50, s2, 3
  s_mov_b32 s96, 4096
  s_mov_b32 s97, 8192
  s_mov_b32 s98, 12288
  s_mov_b32 s99, 0
  s_lshl_b32 s52, s48, 11
  s_lshr_b32 s53, s48, 2
  s_and_b32 s54, s48, 3
  s_waitcnt lgkmcnt(0)
  s_mov_b32 s8, s56
  s_mov_b32 s9, s57
  s_mov_b32 s10, 2097152
  s_mov_b32 s11, 0x20000
  s_mov_b32 s12, s58
  s_mov_b32 s13, s59
  s_mov_b32 s14, 1572864
  s_mov_b32 s15, 0x20000
  s_mov_b32 s16, s60
  s_mov_b32 s17, s61
  s_mov_b32 s18, 524288
  s_mov_b32 s19, 0x20000
  s_mov_b32 s20, s64
  s_mov_b32 s21, s65
  s_mov_b32 s22, 1835008
  s_mov_b32 s23, 0x20000
  s_mov_b32 s36, s66
  s_mov_b32 s37, s67
  s_mov_b32 s38, 3584
  s_mov_b32 s39, 0x20000
  s_mov_b32 s24, s68
  s_mov_b32 s25, s69
  s_mov_b32 s26, 1835008
  s_mov_b32 s27, 0x20000
  s_mov_b32 s40, s70
  s_mov_b32 s41, s71
  s_mov_b32 s42, 1024
  s_mov_b32 s43, 0x20000
  s_mov_b32 s32, s72
  s_mov_b32 s33, s73
  s_mov_b32 s34, 2097152
  s_mov_b32 s35, 0x20000
  s_mov_b32 s44, s74
  s_mov_b32 s45, s75
  s_mov_b32 s46, 256
  s_mov_b32 s47, 0x20000
  s_mov_b32 s28, s76
  s_mov_b32 s29, s77
  s_mov_b32 s30, 18874368
  s_mov_b32 s31, 0x20000
  s_mov_b32 s60, 0x3f803f80
  s_cmp_lg_u32 s2, 192
  s_cbranch_scc1 L_nononce
  s_cmp_lg_u32 s48, 0
  s_cbranch_scc1 L_nononce
  v_mov_b32 v1, 0
  buffer_load_dword v2, v1, s[28:31], 0 offen sc1
  s_waitcnt vmcnt(0)
  v_add_u32 v2, 1, v2
  v_max_u32 v2, 1, v2
  s_mov_b64 exec, 1
  buffer_store_dword v2, v1, s[28:31], 0 offen sc1
  buffer_store_dword v2, v1, s[44:47], 0 offen sc1
  s_mov_b64 exec, -1
L_nononce:
  s_cmp_ge_u32 s50, 24
  s_cbranch_scc1 L_p1_idle
  s_mul_i32 s64, s50, 43
  s_lshr_b32 s64, s64, 8
  s_mul_i32 s65, s64, 6
  s_sub_u32 s65, s50, s65
  s_and_b32 s61, s49, 1
  s_mul_i32 s61, s61, 6
  s_add_u32 s65, s65, s61
  s_lshr_b32 s61, s49, 1
  s_lshl_b32 s61, s61, 2
  s_add_u32 s64, s64, s61
  v_lshrrev_b32 v1, 4, v186
  v_lshrrev_b32 v2, 3, v186
  v_and_b32 v3, 7, v186
  s_lshl_b32 s61, s64, 7
  s_lshl_b32 s62, s48, 4
  s_add_u32 s61, s61, s62
  v_add_u32 v2, s61, v2
  v_lshlrev_b32 v2, 10, v2
  v_xor_b32 v3, v3, v1
  v_lshl_add_u32 v128, v3, 4, v2
  v_xor_b32 v3, 4, v3
  v_lshl_add_u32 v129, v3, 4, v2
  v_add_u32 v129, 8192, v129
  s_lshl_b32 s61, s48, 3
  v_add_u32 v2, s61, v1
  v_mul_u32_u24 v2, 3072, v2
  v_and_b32 v3, 15, v186
  v_lshlrev_b32 v4, 2, v1
  v_xor_b32 v3, v3, v4
  v_lshl_add_u32 v2, v3, 4, v2
  s_lshl_b32 s61, s65, 8
  v_add_u32 v130, s61, v2
  v_add_u32 v131, 12288, v130
  s_and_b32 s3, s64, 3
  s_lshl_b32 s3, s3, 1
  s_add_u32 s3, s3, s65
  s_and_b32 s3, s3, 7
  s_add_u32 s66, s3, 0
  s_and_b32 s66, s66, 7
  s_mul_i32 s67, s66, 196608
  s_lshl_b32 s66, s66, 7
  s_add_u32 m0, s52, 0
  s_nop 0
  buffer_load_dwordx4 v128, s[8:11], s66 offen lds
  s_add_u32 m0, s52, 1024
  s_nop 0
  buffer_load_dwordx4 v129, s[8:11], s66 offen lds
  s_add_u32 m0, s52, 16384
  s_nop 0
  buffer_load_dwordx4 v130, s[12:15], s67 offen lds
  s_add_u32 m0, s52, 17408
  s_nop 0
  buffer_load_dwordx4 v131, s[12:15], s67 offen lds
  s_barrier
  s_add_u32 s66, s3, 1
  s_and_b32 s66, s66, 7
  s_mul_i32 s67, s66, 196608
  s_lshl_b32 s66, s66, 7
  s_add_u32 m0, s52, 32768
  s_nop 0
  buffer_load_dwordx4 v128, s[8:11], s66 offen lds
  s_add_u32 m0, s52, 33792
  s_nop 0
  buffer_load_dwordx4 v129, s[8:11], s66 offen lds
  s_add_u32 m0, s52, 49152
  s_nop 0
  buffer_load_dwordx4 v130, s[12:15], s67 offen lds
  s_add_u32 m0, s52, 50176
  s_nop 0
  buffer_load_dwordx4 v131, s[12:15], s67 offen lds
  s_lshr_b32 s56, s50, 3
  s_lshl_b32 s63, s49, 2
  s_add_u32 s56, s56, s63
  s_and_b32 s57, s50, 7
  s_cmp_ge_u32 s50, 14
  s_cselect_b32 s58, 1, 0
  s_mul_i32 s63, s58, 14
  s_sub_u32 s59, s50, s63
  s_lshl_b32 s63, s49, 1
  s_add_u32 s58, s58, s63
  v_lshrrev_b32 v32, 3, v186
  v_bfe_u32 v33, v186, 4, 1
  v_lshlrev_b32 v33, 2, v33
  v_and_b32 v34, 7, v186
  v_xor_b32 v33, v33, v34
  s_lshl_b32 s63, s53, 3
  v_add_u32 v32, s63, v32
  v_lshlrev_b32 v32, 10, v32
  v_lshl_add_u32 v32, v33, 4, v32
  s_lshl_b32 s63, s57, 7
  v_add_u32 v172, s63, v32
  s_lshl_b32 s100, s54, 13
  s_lshl_b32 s63, s53, 10
  s_add_u32 s100, s100, s63
  s_lshl_b32 s101, s54, 17
  s_lshl_b32 s7, s58, 2
  s_add_u32 s7, s7, s59
  v_lshrrev_b32 v32, 4, v186
  v_and_b32 v33, 15, v186
  v_lshlrev_b32 v34, 2, v32
  v_xor_b32 v33, v33, v34
  s_lshl_b32 s63, s48, 2
  v_add_u32 v32, s63, v32
  v_mul_u32_u24 v32, 3584, v32
  v_lshl_add_u32 v32, v33, 4, v32
  s_lshl_b32 s63, s59, 8
  v_add_u32 v173, s63, v32
  s_lshl_b32 s6, s48, 10
  s_cmp_lt_u32 s50, 28
  s_cbranch_scc1 L_w1ok
  v_mov_b32 v173, 0x7ff00000
L_w1ok:
  v_bfe_u32 v32, v186, 2, 2
  v_lshrrev_b32 v33, 5, v186
  v_lshl_add_u32 v33, v33, 2, v32
  v_lshlrev_b32 v33, 7, v33
  v_bfe_u32 v34, v186, 4, 1
  v_add_u32 v34, s54, v34
  v_and_b32 v34, 3, v34
  v_lshlrev_b32 v34, 1, v34
  v_bfe_u32 v35, v186, 1, 1
  v_add_u32 v34, v34, v35
  v_lshrrev_b32 v35, 1, v32
  v_lshlrev_b32 v35, 2, v35
  v_xor_b32 v34, v34, v35
  v_lshl_add_u32 v33, v34, 4, v33
  v_and_b32 v35, 1, v186
  v_lshl_add_u32 v174, v35, 3, v33
  v_xor_b32 v175, 64, v174
  s_lshl_b32 s62, s54, 13
  v_add_u32 v176, s62, v174
  v_add_u32 v177, s62, v175
  s_lshl_b32 s61, s53, 1
  s_add_u32 s61, s61, s54
  v_and_b32 v1, 31, v186
  v_lshrrev_b32 v2, 5, v186
  v_bfe_u32 v3, v186, 1, 3
  v_xor_b32 v3, v3, v2
  s_lshl_b32 s62, s53, 13
  v_lshl_add_u32 v4, v1, 7, s62
  v_bfe_u32 v5, v186, 2, 2
  v_lshl_add_u32 v6, v2, 3, v5
  v_lshlrev_b32 v6, 8, v6
  v_xor_b32 v7, s54, v5
  v_lshlrev_b32 v7, 2, v7
  v_bfe_u32 v8, v186, 4, 1
  v_lshl_add_u32 v7, v8, 1, v7
  v_bfe_u32 v8, v186, 1, 1
  v_add_u32 v7, v7, v8
  v_lshl_add_u32 v6, v7, 4, v6
  v_and_b32 v8, 1, v186
  v_lshl_add_u32 v6, v8, 3, v6
  v_add_u32 v6, 16384, v6
  s_add_u32 s62, s61, 0
  s_and_b32 s62, s62, 3
  s_lshl_b32 s63, s62, 1
  v_xor_b32 v8, s63, v3
  v_lshl_add_u32 v132, v8, 4, v4
  s_lshl_b32 s63, s62, 12
  v_add_u32 v140, s63, v6
  v_add_u32 v136, 0x10000, v132
  v_add_u32 v144, 0x10000, v140
  s_add_u32 s62, s61, 1
  s_and_b32 s62, s62, 3
  s_lshl_b32 s63, s62, 1
  v_xor_b32 v8, s63, v3
  v_lshl_add_u32 v133, v8, 4, v4
  s_lshl_b32 s63, s62, 12
  v_add_u32 v141, s63, v6
  v_add_u32 v137, 0x10000, v133
  v_add_u32 v145, 0x10000, v141
  s_add_u32 s62, s61, 2
  s_and_b32 s62, s62, 3
  s_lshl_b32 s63, s62, 1
  v_xor_b32 v8, s63, v3
  v_lshl_add_u32 v134, v8, 4, v4
  s_lshl_b32 s63, s62, 12
  v_add_u32 v142, s63, v6
  v_add_u32 v138, 0x10000, v134
  v_add_u32 v146, 0x10000, v142
  s_add_u32 s62, s61, 3
  s_and_b32 s62, s62, 3
  s_lshl_b32 s63, s62, 1
  v_xor_b32 v8, s63, v3
  v_lshl_add_u32 v135, v8, 4, v4
  s_lshl_b32 s63, s62, 12
  v_add_u32 v143, s63, v6
  v_add_u32 v139, 0x10000, v135
  v_add_u32 v147, 0x10000, v143
  s_lshl_b32 s61, s64, 1
  s_add_u32 s61, s61, s53
  s_lshl_b32 s61, s61, 10
  s_add_u32 s61, s61, 196608
  v_lshl_add_u32 v156, v1, 4, s61
  v_mov_b32 v168, 0x3f803f80
  v_mov_b32 v169, 0x3f803f80
  s_cmp_ge_u32 s65, 8
  s_cbranch_scc1 L_p1_v
  s_waitcnt vmcnt(4)
  s_barrier
  ds_read_b128 v[32:35], v132 offset:0
  ds_read_b64_tr_b16 v[40:41], v140 offset:0
  ds_read_b64_tr_b16 v[42:43], v140 offset:1024
  ds_read_b128 v[36:39], v132 offset:4096
  ds_read_b128 v[44:47], v133 offset:0
  ds_read_b64_tr_b16 v[52:53], v141 offset:0
  ds_read_b64_tr_b16 v[54:55], v141 offset:1024
  ds_read_b128 v[48:51], v133 offset:4096
  ds_read_b128 v[56:59], v134 offset:0
  ds_read_b64_tr_b16 v[64:65], v142 offset:0
  ds_read_b64_tr_b16 v[66:67], v142 offset:1024
  ds_read_b128 v[60:63], v134 offset:4096
  ds_read_b128 v[68:71], v135 offset:0
  ds_read_b64_tr_b16 v[76:77], v143 offset:0
  ds_read_b64_tr_b16 v[78:79], v143 offset:1024
  ds_read_b128 v[72:75], v135 offset:4096
  s_waitcnt lgkmcnt(0)
  s_waitcnt vmcnt(0)
  s_barrier
  v_mfma_f32_32x32x16_bf16 v[0:15], v[40:43], v[32:35], 0
  v_mfma_f32_4x4x4_16b_bf16 v[160:163], v[168:169], v[40:41], 0
  ds_read_b128 v[80:83], v132 offset:32768
  ds_read_b64_tr_b16 v[88:89], v140 offset:32768
  ds_read_b64_tr_b16 v[90:91], v140 offset:33792
  s_add_u32 s66, s3, 2
  s_and_b32 s66, s66, 7
  s_mul_i32 s67, s66, 196608
  s_lshl_b32 s66, s66, 7
  s_add_u32 m0, s52, 65536
  s_nop 0
  buffer_load_dwordx4 v128, s[8:11], s66 offen lds
  v_mfma_f32_32x32x16_bf16 v[16:31], v[40:43], v[36:39], 0
  ds_read_b128 v[84:87], v132 offset:36864
  ds_read_b128 v[92:95], v133 offset:32768
  ds_read_b64_tr_b16 v[100:101], v141 offset:32768
  s_add_u32 m0, s52, 66560
  s_nop 0
  buffer_load_dwordx4 v129, s[8:11], s66 offen lds
  v_mfma_f32_32x32x16_bf16 v[0:15], v[52:55], v[44:47], v[0:15]
  v_mfma_f32_4x4x4_16b_bf16 v[164:167], v[168:169], v[52:53], 0
  ds_read_b64_tr_b16 v[102:103], v141 offset:33792
  ds_read_b128 v[96:99], v133 offset:36864
  ds_read_b128 v[104:107], v134 offset:32768
  s_add_u32 m0, s52, 81920
  s_nop 0
  buffer_load_dwordx4 v130, s[12:15], s67 offen lds
  v_mfma_f32_32x32x16_bf16 v[16:31], v[52:55], v[48:51], v[16:31]
  ds_read_b64_tr_b16 v[112:113], v142 offset:32768
  ds_read_b64_tr_b16 v[114:115], v142 offset:33792
  ds_read_b128 v[108:111], v134 offset:36864
  s_add_u32 m0, s52, 82944
  s_nop 0
  buffer_load_dwordx4 v131, s[12:15], s67 offen lds
  v_mfma_f32_32x32x16_bf16 v[0:15], v[64:67], v[56:59], v[0:15]
  v_mfma_f32_4x4x4_16b_bf16 v[160:163], v[168:169], v[42:43], v[160:163]
  ds_read_b128 v[116:119], v135 offset:32768
  ds_read_b64_tr_b16 v[124:125], v143 offset:32768
  ds_read_b64_tr_b16 v[126:127], v143 offset:33792
  s_add_u32 s66, s3, 3
  s_and_b32 s66, s66, 7
  s_mul_i32 s67, s66, 196608
  s_lshl_b32 s66, s66, 7
  s_add_u32 m0, s52, 98304
  s_nop 0
  buffer_load_dwordx4 v128, s[8:11], s66 offen lds
  v_mfma_f32_32x32x16_bf16 v[16:31], v[64:67], v[60:63], v[16:31]
  ds_read_b128 v[120:123], v135 offset:36864
  s_add_u32 m0, s52, 99328
  s_nop 0
  buffer_load_dwordx4 v129, s[8:11], s66 offen lds
  v_mfma_f32_32x32x16_bf16 v[0:15], v[76:79], v[68:71], v[0:15]
  v_mfma_f32_4x4x4_16b_bf16 v[164:167], v[168:169], v[54:55], v[164:167]
  s_add_u32 m0, s52, 114688
  s_nop 0
  buffer_load_dwordx4 v130, s[12:15], s67 offen lds
  v_mfma_f32_32x32x16_bf16 v[16:31], v[76:79], v[72:75], v[16:31]
  s_add_u32 m0, s52, 115712
  s_nop 0
  buffer_load_dwordx4 v131, s[12:15], s67 offen lds
  s_waitcnt lgkmcnt(0)
  s_waitcnt vmcnt(4)
  s_barrier
  v_mfma_f32_32x32x16_bf16 v[0:15], v[88:91], v[80:83], v[0:15]
  v_mfma_f32_4x4x4_16b_bf16 v[160:163], v[168:169], v[88:89], v[160:163]
  ds_read_b128 v[32:35], v136 offset:0
  ds_read_b64_tr_b16 v[40:41], v144 offset:0
  ds_read_b64_tr_b16 v[42:43], v144 offset:1024
  s_add_u32 s66, s3, 4
  s_and_b32 s66, s66, 7
  s_mul_i32 s67, s66, 196608
  s_lshl_b32 s66, s66, 7
  s_add_u32 m0, s52, 0
  s_nop 0
  buffer_load_dwordx4 v128, s[8:11], s66 offen lds
  v_mfma_f32_32x32x16_bf16 v[16:31], v[88:91], v[84:87], v[16:31]
  ds_read_b128 v[36:39], v136 offset:4096
  ds_read_b128 v[44:47], v137 offset:0
  ds_read_b64_tr_b16 v[52:53], v145 offset:0
  v_mfma_f32_32x32x16_bf16 v[0:15], v[100:103], v[92:95], v[0:15]
  v_mfma_f32_4x4x4_16b_bf16 v[164:167], v[168:169], v[100:101], v[164:167]
  ds_read_b64_tr_b16 v[54:55], v145 offset:1024
  ds_read_b128 v[48:51], v137 offset:4096
  ds_read_b128 v[56:59], v138 offset:0
  s_add_u32 m0, s52, 1024
  s_nop 0
  buffer_load_dwordx4 v129, s[8:11], s66 offen lds
  v_mfma_f32_32x32x16_bf16 v[16:31], v[100:103], v[96:99], v[16:31]
  ds_read_b64_tr_b16 v[64:65], v146 offset:0
  ds_read_b64_tr_b16 v[66:67], v146 offset:1024
  ds_read_b128 v[60:63], v138 offset:4096
  v_mfma_f32_32x32x16_bf16 v[0:15], v[112:115], v[104:107], v[0:15]
  v_mfma_f32_4x4x4_16b_bf16 v[160:163], v[168:169], v[90:91], v[160:163]
  ds_read_b128 v[68:71], v139 offset:0
  ds_read_b64_tr_b16 v[76:77], v147 offset:0
  ds_read_b64_tr_b16 v[78:79], v147 offset:1024
  s_add_u32 m0, s52, 16384
  s_nop 0
  buffer_load_dwordx4 v130, s[12:15], s67 offen lds
  v_mfma_f32_32x32x16_bf16 v[16:31], v[112:115], v[108:111], v[16:31]
  ds_read_b128 v[72:75], v139 offset:4096
  v_mfma_f32_32x32x16_bf16 v[0:15], v[124:127], v[116:119], v[0:15]
  v_mfma_f32_4x4x4_16b_bf16 v[164:167], v[168:169], v[102:103], v[164:167]
  s_add_u32 m0, s52, 17408
  s_nop 0
  buffer_load_dwordx4 v131, s[12:15], s67 offen lds
  v_mfma_f32_32x32x16_bf16 v[16:31], v[124:127], v[120:123], v[16:31]
  s_waitcnt lgkmcnt(0)
  s_waitcnt vmcnt(4)
  s_barrier
  v_mfma_f32_32x32x16_bf16 v[0:15], v[40:43], v[32:35], v[0:15]
  v_mfma_f32_4x4x4_16b_bf16 v[160:163], v[168:169], v[40:41], v[160:163]
  ds_read_b128 v[80:83], v136 offset:32768
  ds_read_b64_tr_b16 v[88:89], v144 offset:32768
  ds_read_b64_tr_b16 v[90:91], v144 offset:33792
  s_add_u32 s66, s3, 5
  s_and_b32 s66, s66, 7
  s_mul_i32 s67, s66, 196608
  s_lshl_b32 s66, s66, 7
  s_add_u32 m0, s52, 32768
  s_nop 0
  buffer_load_dwordx4 v128, s[8:11], s66 offen lds
  v_mfma_f32_32x32x16_bf16 v[16:31], v[40:43], v[36:39], v[16:31]
  ds_read_b128 v[84:87], v136 offset:36864
  ds_read_b128 v[92:95], v137 offset:32768
  ds_read_b64_tr_b16 v[100:101], v145 offset:32768
  v_mfma_f32_32x32x16_bf16 v[0:15], v[52:55], v[44:47], v[0:15]
  v_mfma_f32_4x4x4_16b_bf16 v[164:167], v[168:169], v[52:53], v[164:167]
  ds_read_b64_tr_b16 v[102:103], v145 offset:33792
  ds_read_b128 v[96:99], v137 offset:36864
  ds_read_b128 v[104:107], v138 offset:32768
  s_add_u32 m0, s52, 33792
  s_nop 0
  buffer_load_dwordx4 v129, s[8:11], s66 offen lds
  v_mfma_f32_32x32x16_bf16 v[16:31], v[52:55], v[48:51], v[16:31]
  ds_read_b64_tr_b16 v[112:113], v146 offset:32768
  ds_read_b64_tr_b16 v[114:115], v146 offset:33792
  ds_read_b128 v[108:111], v138 offset:36864
  v_mfma_f32_32x32x16_bf16 v[0:15], v[64:67], v[56:59], v[0:15]
  v_mfma_f32_4x4x4_16b_bf16 v[160:163], v[168:169], v[42:43], v[160:163]
  ds_read_b128 v[116:119], v139 offset:32768
  ds_read_b64_tr_b16 v[124:125], v147 offset:32768
  ds_read_b64_tr_b16 v[126:127], v147 offset:33792
  s_add_u32 m0, s52, 49152
  s_nop 0
  buffer_load_dwordx4 v130, s[12:15], s67 offen lds
  v_mfma_f32_32x32x16_bf16 v[16:31], v[64:67], v[60:63], v[16:31]
  ds_read_b128 v[120:123], v139 offset:36864
  v_mfma_f32_32x32x16_bf16 v[0:15], v[76:79], v[68:71], v[0:15]
  v_mfma_f32_4x4x4_16b_bf16 v[164:167], v[168:169], v[54:55], v[164:167]
  s_add_u32 m0, s52, 50176
  s_nop 0
  buffer_load_dwordx4 v131, s[12:15], s67 offen lds
  v_mfma_f32_32x32x16_bf16 v[16:31], v[76:79], v[72:75], v[16:31]
  v_mov_b32 v170, 0
  buffer_load_dword v171, v170, s[44:47], 0 offen sc1
  s_waitcnt lgkmcnt(0)
  s_waitcnt vmcnt(4)
  s_barrier
  v_mfma_f32_32x32x16_bf16 v[0:15], v[88:91], v[80:83], v[0:15]
  v_mfma_f32_4x4x4_16b_bf16 v[160:163], v[168:169], v[88:89], v[160:163]
  ds_read_b128 v[32:35], v132 offset:0
  ds_read_b64_tr_b16 v[40:41], v140 offset:0
  ds_read_b64_tr_b16 v[42:43], v140 offset:1024
  s_add_u32 s66, s3, 6
  s_and_b32 s66, s66, 7
  s_mul_i32 s67, s66, 196608
  s_lshl_b32 s66, s66, 7
  s_add_u32 m0, s52, 65536
  s_nop 0
  buffer_load_dwordx4 v128, s[8:11], s66 offen lds
  v_mfma_f32_32x32x16_bf16 v[16:31], v[88:91], v[84:87], v[16:31]
  ds_read_b128 v[36:39], v132 offset:4096
  ds_read_b128 v[44:47], v133 offset:0
  ds_read_b64_tr_b16 v[52:53], v141 offset:0
  v_mfma_f32_32x32x16_bf16 v[0:15], v[100:103], v[92:95], v[0:15]
  v_mfma_f32_4x4x4_16b_bf16 v[164:167], v[168:169], v[100:101], v[164:167]
  ds_read_b64_tr_b16 v[54:55], v141 offset:1024
  ds_read_b128 v[48:51], v133 offset:4096
  ds_read_b128 v[56:59], v134 offset:0
  s_add_u32 m0, s52, 66560
  s_nop 0
  buffer_load_dwordx4 v129, s[8:11], s66 offen lds
  v_mfma_f32_32x32x16_bf16 v[16:31], v[100:103], v[96:99], v[16:31]
  ds_read_b64_tr_b16 v[64:65], v142 offset:0
  ds_read_b64_tr_b16 v[66:67], v142 offset:1024
  ds_read_b128 v[60:63], v134 offset:4096
  v_mfma_f32_32x32x16_bf16 v[0:15], v[112:115], v[104:107], v[0:15]
  v_mfma_f32_4x4x4_16b_bf16 v[160:163], v[168:169], v[90:91], v[160:163]
  ds_read_b128 v[68:71], v135 offset:0
  ds_read_b64_tr_b16 v[76:77], v143 offset:0
  ds_read_b64_tr_b16 v[78:79], v143 offset:1024
  s_add_u32 m0, s52, 81920
  s_nop 0
  buffer_load_dwordx4 v130, s[12:15], s67 offen lds
  v_mfma_f32_32x32x16_bf16 v[16:31], v[112:115], v[108:111], v[16:31]
  ds_read_b128 v[72:75], v135 offset:4096
  v_mfma_f32_32x32x16_bf16 v[0:15], v[124:127], v[116:119], v[0:15]
  v_mfma_f32_4x4x4_16b_bf16 v[164:167], v[168:169], v[102:103], v[164:167]
  s_add_u32 m0, s52, 82944
  s_nop 0
  buffer_load_dwordx4 v131, s[12:15], s67 offen lds
  v_mfma_f32_32x32x16_bf16 v[16:31], v[124:127], v[120:123], v[16:31]
  s_waitcnt lgkmcnt(0)
  s_waitcnt vmcnt(4)
  s_barrier
  v_mfma_f32_32x32x16_bf16 v[0:15], v[40:43], v[32:35], v[0:15]
  v_mfma_f32_4x4x4_16b_bf16 v[160:163], v[168:169], v[40:41], v[160:163]
  ds_read_b128 v[80:83], v132 offset:32768
  ds_read_b64_tr_b16 v[88:89], v140 offset:32768
  ds_read_b64_tr_b16 v[90:91], v140 offset:33792
  s_add_u32 s66, s3, 7
  s_and_b32 s66, s66, 7
  s_mul_i32 s67, s66, 196608
  s_lshl_b32 s66, s66, 7
  s_add_u32 m0, s52, 98304
  s_nop 0
  buffer_load_dwordx4 v128, s[8:11], s66 offen lds
  v_mfma_f32_32x32x16_bf16 v[16:31], v[40:43], v[36:39], v[16:31]
  ds_read_b128 v[84:87], v132 offset:36864
  ds_read_b128 v[92:95], v133 offset:32768
  ds_read_b64_tr_b16 v[100:101], v141 offset:32768
  v_mfma_f32_32x32x16_bf16 v[0:15], v[52:55], v[44:47], v[0:15]
  v_mfma_f32_4x4x4_16b_bf16 v[164:167], v[168:169], v[52:53], v[164:167]
  ds_read_b64_tr_b16 v[102:103], v141 offset:33792
  ds_read_b128 v[96:99], v133 offset:36864
  ds_read_b128 v[104:107], v134 offset:32768
  s_add_u32 m0, s52, 99328
  s_nop 0
  buffer_load_dwordx4 v129, s[8:11], s66 offen lds
  v_mfma_f32_32x32x16_bf16 v[16:31], v[52:55], v[48:51], v[16:31]
  ds_read_b64_tr_b16 v[112:113], v142 offset:32768
  ds_read_b64_tr_b16 v[114:115], v142 offset:33792
  ds_read_b128 v[108:111], v134 offset:36864
  v_mfma_f32_32x32x16_bf16 v[0:15], v[64:67], v[56:59], v[0:15]
  v_mfma_f32_4x4x4_16b_bf16 v[160:163], v[168:169], v[42:43], v[160:163]
  ds_read_b128 v[116:119], v135 offset:32768
  ds_read_b64_tr_b16 v[124:125], v143 offset:32768
  ds_read_b64_tr_b16 v[126:127], v143 offset:33792
  s_add_u32 m0, s52, 114688
  s_nop 0
  buffer_load_dwordx4 v130, s[12:15], s67 offen lds
  v_mfma_f32_32x32x16_bf16 v[16:31], v[64:67], v[60:63], v[16:31]
  ds_read_b128 v[120:123], v135 offset:36864
  v_mfma_f32_32x32x16_bf16 v[0:15], v[76:79], v[68:71], v[0:15]
  v_mfma_f32_4x4x4_16b_bf16 v[164:167], v[168:169], v[54:55], v[164:167]
  s_add_u32 m0, s52, 115712
  s_nop 0
  buffer_load_dwordx4 v131, s[12:15], s67 offen lds
  v_mfma_f32_32x32x16_bf16 v[16:31], v[76:79], v[72:75], v[16:31]
  s_waitcnt lgkmcnt(0)
  s_waitcnt vmcnt(4)
  s_barrier
  v_mfma_f32_32x32x16_bf16 v[0:15], v[88:91], v[80:83], v[0:15]
  v_mfma_f32_4x4x4_16b_bf16 v[160:163], v[168:169], v[88:89], v[160:163]
  ds_read_b128 v[32:35], v136 offset:0
  ds_read_b64_tr_b16 v[40:41], v144 offset:0
  ds_read_b64_tr_b16 v[42:43], v144 offset:1024
  buffer_load_dwordx4 v[148:151], v156, s[28:31], 0 offen sc1
  buffer_load_dwordx4 v[152:155], v156, s[28:31], 0 offen offset:512 sc1
  s_add_u32 s63, s101, 0
  s_add_u32 m0, s100, 0
  s_nop 0
  buffer_load_dwordx4 v172, s[16:19], s63 offen lds
  v_mfma_f32_32x32x16_bf16 v[16:31], v[88:91], v[84:87], v[16:31]
  ds_read_b128 v[36:39], v136 offset:4096
  ds_read_b128 v[44:47], v137 offset:0
  ds_read_b64_tr_b16 v[52:53], v145 offset:0
  v_mfma_f32_32x32x16_bf16 v[0:15], v[100:103], v[92:95], v[0:15]
  v_mfma_f32_4x4x4_16b_bf16 v[164:167], v[168:169], v[100:101], v[164:167]
  ds_read_b64_tr_b16 v[54:55], v145 offset:1024
  ds_read_b128 v[48:51], v137 offset:4096
  ds_read_b128 v[56:59], v138 offset:0
  s_add_u32 s63, s101, 16384
  s_add_u32 m0, s100, 2048
  s_nop 0
  buffer_load_dwordx4 v172, s[16:19], s63 offen lds
  v_mfma_f32_32x32x16_bf16 v[16:31], v[100:103], v[96:99], v[16:31]
  ds_read_b64_tr_b16 v[64:65], v146 offset:0
  ds_read_b64_tr_b16 v[66:67], v146 offset:1024
  ds_read_b128 v[60:63], v138 offset:4096
  v_mfma_f32_32x32x16_bf16 v[0:15], v[112:115], v[104:107], v[0:15]
  v_mfma_f32_4x4x4_16b_bf16 v[160:163], v[168:169], v[90:91], v[160:163]
  ds_read_b128 v[68:71], v139 offset:0
  ds_read_b64_tr_b16 v[76:77], v147 offset:0
  ds_read_b64_tr_b16 v[78:79], v147 offset:1024
  s_add_u32 s63, s101, 32768
  s_add_u32 m0, s100, 4096
  s_nop 0
  buffer_load_dwordx4 v172, s[16:19], s63 offen lds
  v_mfma_f32_32x32x16_bf16 v[16:31], v[112:115], v[108:111], v[16:31]
  ds_read_b128 v[72:75], v139 offset:4096
  v_mfma_f32_32x32x16_bf16 v[0:15], v[124:127], v[116:119], v[0:15]
  v_mfma_f32_4x4x4_16b_bf16 v[164:167], v[168:169], v[102:103], v[164:167]
  s_add_u32 s63, s101, 49152
  s_add_u32 m0, s100, 6144
  s_nop 0
  buffer_load_dwordx4 v172, s[16:19], s63 offen lds
  v_mfma_f32_32x32x16_bf16 v[16:31], v[124:127], v[120:123], v[16:31]
  s_waitcnt lgkmcnt(0)
  s_waitcnt vmcnt(6)
  s_barrier
  v_mfma_f32_32x32x16_bf16 v[0:15], v[40:43], v[32:35], v[0:15]
  v_mfma_f32_4x4x4_16b_bf16 v[160:163], v[168:169], v[40:41], v[160:163]
  ds_read_b128 v[80:83], v136 offset:32768
  ds_read_b64_tr_b16 v[88:89], v144 offset:32768
  ds_read_b64_tr_b16 v[90:91], v144 offset:33792
  s_add_u32 s63, s101, 65536
  s_add_u32 m0, s100, 32768
  s_nop 0
  buffer_load_dwordx4 v172, s[16:19], s63 offen lds
  v_mfma_f32_32x32x16_bf16 v[16:31], v[40:43], v[36:39], v[16:31]
  ds_read_b128 v[84:87], v136 offset:36864
  ds_read_b128 v[92:95], v137 offset:32768
  ds_read_b64_tr_b16 v[100:101], v145 offset:32768
  v_mfma_f32_32x32x16_bf16 v[0:15], v[52:55], v[44:47], v[0:15]
  v_mfma_f32_4x4x4_16b_bf16 v[164:167], v[168:169], v[52:53], v[164:167]
  ds_read_b64_tr_b16 v[102:103], v145 offset:33792
  ds_read_b128 v[96:99], v137 offset:36864
  ds_read_b128 v[104:107], v138 offset:32768
  s_add_u32 s63, s101, 81920
  s_add_u32 m0, s100, 34816
  s_nop 0
  buffer_load_dwordx4 v172, s[16:19], s63 offen lds
  v_mfma_f32_32x32x16_bf16 v[16:31], v[52:55], v[48:51], v[16:31]
  ds_read_b64_tr_b16 v[112:113], v146 offset:32768
  ds_read_b64_tr_b16 v[114:115], v146 offset:33792
  ds_read_b128 v[108:111], v138 offset:36864
  v_mfma_f32_32x32x16_bf16 v[0:15], v[64:67], v[56:59], v[0:15]
  v_mfma_f32_4x4x4_16b_bf16 v[160:163], v[168:169], v[42:43], v[160:163]
  ds_read_b128 v[116:119], v139 offset:32768
  ds_read_b64_tr_b16 v[124:125], v147 offset:32768
  ds_read_b64_tr_b16 v[126:127], v147 offset:33792
  s_add_u32 s63, s101, 98304
  s_add_u32 m0, s100, 36864
  s_nop 0
  buffer_load_dwordx4 v172, s[16:19], s63 offen lds
  v_mfma_f32_32x32x16_bf16 v[16:31], v[64:67], v[60:63], v[16:31]
  ds_read_b128 v[120:123], v139 offset:36864
  v_mfma_f32_32x32x16_bf16 v[0:15], v[76:79], v[68:71], v[0:15]
  v_mfma_f32_4x4x4_16b_bf16 v[164:167], v[168:169], v[54:55], v[164:167]
  s_add_u32 s63, s101, 114688
  s_add_u32 m0, s100, 38912
  s_nop 0
  buffer_load_dwordx4 v172, s[16:19], s63 offen lds
  v_mfma_f32_32x32x16_bf16 v[16:31], v[76:79], v[72:75], v[16:31]
  s_waitcnt lgkmcnt(0)
  v_mfma_f32_32x32x16_bf16 v[0:15], v[88:91], v[80:83], v[0:15]
  v_mfma_f32_4x4x4_16b_bf16 v[160:163], v[168:169], v[88:89], v[160:163]
  v_mfma_f32_32x32x16_bf16 v[16:31], v[88:91], v[84:87], v[16:31]
  v_mfma_f32_4x4x4_16b_bf16 v[164:167], v[168:169], v[100:101], v[164:167]
  v_mfma_f32_32x32x16_bf16 v[0:15], v[100:103], v[92:95], v[0:15]
  v_mfma_f32_4x4x4_16b_bf16 v[160:163], v[168:169], v[90:91], v[160:163]
  v_mfma_f32_32x32x16_bf16 v[16:31], v[100:103], v[96:99], v[16:31]
  v_mfma_f32_4x4x4_16b_bf16 v[164:167], v[168:169], v[102:103], v[164:167]
  v_mfma_f32_32x32x16_bf16 v[0:15], v[112:115], v[104:107], v[0:15]
  v_and_b32 v33, 31, v186
  s_lshl_b32 s61, s54, 7
  s_add_u32 s61, s61, 135168
  v_lshl_add_u32 v36, v33, 2, s61
  v_mfma_f32_32x32x16_bf16 v[16:31], v[112:115], v[108:111], v[16:31]
  s_lshl_b32 s62, s53, 9
  v_add_u32 v37, s62, v36
  v_add_f32 v160, v160, v164
  v_mov_b32 v34, v160
  v_mfma_f32_32x32x16_bf16 v[0:15], v[124:127], v[116:119], v[0:15]
  s_nop 1
  v_permlane32_swap_b32 v34, v160
  s_nop 1
  v_add_f32 v160, v160, v34
  v_mfma_f32_32x32x16_bf16 v[16:31], v[124:127], v[120:123], v[16:31]
  ds_write_b32 v37, v160
  s_mov_b32 s55, 0x40000
na_1:
  v_readfirstlane_b32 s51, v171
  s_cmp_lg_u32 s51, 0
  s_cbranch_scc1 nad_2
  s_sleep 16
  buffer_load_dword v171, v170, s[44:47], 0 offen sc1
  s_waitcnt vmcnt(0)
  s_sub_u32 s55, s55, 1
  s_cmp_lg_u32 s55, 0
  s_cbranch_scc1 na_1
  s_mov_b32 s99, 1
nad_2:
  s_waitcnt vmcnt(0) lgkmcnt(0)
  s_barrier
  v_lshrrev_b32 v38, 5, v186
  s_lshl_b32 s61, s54, 7
  s_add_u32 s61, s61, 135168
  v_lshl_add_u32 v38, v38, 4, s61
  ds_read_b128 v[64:67], v38 offset:0
  ds_read_b128 v[80:83], v38 offset:512
  ds_read_b128 v[68:71], v38 offset:32
  ds_read_b128 v[84:87], v38 offset:544
  ds_read_b128 v[72:75], v38 offset:64
  ds_read_b128 v[88:91], v38 offset:576
  ds_read_b128 v[76:79], v38 offset:96
  ds_read_b128 v[92:95], v38 offset:608
  s_mov_b32 s55, 0x40000
xs_3:
  v_cmp_ne_u32 vcc, s51, v150
  v_cmp_ne_u32 s[4:5], s51, v154
  s_nop 1
  s_or_b64 vcc, vcc, s[4:5]
  s_cbranch_vccz xsd_4
  s_sleep 4
  buffer_load_dwordx4 v[148:151], v156, s[28:31], 0 offen sc1
  buffer_load_dwordx4 v[152:155], v156, s[28:31], 0 offen offset:512 sc1
  s_waitcnt vmcnt(0)
  s_sub_u32 s55, s55, 1
  s_cmp_lg_u32 s55, 0
  s_cbranch_scc1 xs_3
  s_mov_b32 s99, 1
xsd_4:
  v_mov_b32 v40, v148
  v_mov_b32 v41, v152
  v_mov_b32 v42, v149
  v_mov_b32 v43, v153
  s_mov_b32 s61, 1.0
  s_cmp_lt_u32 s65, 4
  s_cselect_b32 s61, 0x3eb8aa3b, s61
  s_and_b32 s62, s65, 3
  s_lshr_b32 s63, s65, 2
  v_mul_f32 v42, s61, v42
  v_mul_f32 v43, s61, v43
  s_waitcnt lgkmcnt(0)
  v_pk_add_f32 v[64:65], v[64:65], v[80:81]
  v_pk_add_f32 v[66:67], v[66:67], v[82:83]
  v_pk_add_f32 v[68:69], v[68:69], v[84:85]
  v_pk_add_f32 v[70:71], v[70:71], v[86:87]
  v_pk_add_f32 v[72:73], v[72:73], v[88:89]
  v_pk_add_f32 v[74:75], v[74:75], v[90:91]
  v_pk_add_f32 v[76:77], v[76:77], v[92:93]
  v_pk_add_f32 v[78:79], v[78:79], v[94:95]
  s_lshl_b32 s63, s63, 21
  s_add_u32 s63, s63, 1048576
  s_lshl_b32 s62, s62, 3
  s_lshl_b32 s61, s54, 1
  s_add_u32 s62, s62, s61
  s_lshl_b32 s61, s64, 1
  s_add_u32 s61, s61, s53
  s_lshl_b32 s61, s61, 6
  s_add_u32 s62, s62, s61
  s_lshl_b32 s62, s62, 10
  s_add_u32 s62, s62, s63
  s_add_u32 s63, s62, 32768
  v_lshlrev_b32 v39, 4, v186
  v_pk_fma_f32 v[0:1], v[64:65], v[40:41], v[0:1] op_sel_hi:[1,0,1] neg_lo:[0,1,0] neg_hi:[0,1,0]
  v_pk_fma_f32 v[2:3], v[66:67], v[40:41], v[2:3] op_sel_hi:[1,0,1] neg_lo:[0,1,0] neg_hi:[0,1,0]
  v_pk_fma_f32 v[4:5], v[68:69], v[40:41], v[4:5] op_sel_hi:[1,0,1] neg_lo:[0,1,0] neg_hi:[0,1,0]
  v_pk_fma_f32 v[6:7], v[70:71], v[40:41], v[6:7] op_sel_hi:[1,0,1] neg_lo:[0,1,0] neg_hi:[0,1,0]
  v_pk_fma_f32 v[8:9], v[72:73], v[40:41], v[8:9] op_sel_hi:[1,0,1] neg_lo:[0,1,0] neg_hi:[0,1,0]
  v_pk_fma_f32 v[10:11], v[74:75], v[40:41], v[10:11] op_sel_hi:[1,0,1] neg_lo:[0,1,0] neg_hi:[0,1,0]
  v_pk_fma_f32 v[12:13], v[76:77], v[40:41], v[12:13] op_sel_hi:[1,0,1] neg_lo:[0,1,0] neg_hi:[0,1,0]
  v_pk_fma_f32 v[14:15], v[78:79], v[40:41], v[14:15] op_sel_hi:[1,0,1] neg_lo:[0,1,0] neg_hi:[0,1,0]
  v_pk_mul_f32 v[0:1], v[0:1], v[42:43] op_sel_hi:[1,0]
  v_pk_mul_f32 v[2:3], v[2:3], v[42:43] op_sel_hi:[1,0]
  v_pk_mul_f32 v[4:5], v[4:5], v[42:43] op_sel_hi:[1,0]
  v_pk_mul_f32 v[6:7], v[6:7], v[42:43] op_sel_hi:[1,0]
  v_pk_mul_f32 v[8:9], v[8:9], v[42:43] op_sel_hi:[1,0]
  v_pk_mul_f32 v[10:11], v[10:11], v[42:43] op_sel_hi:[1,0]
  v_pk_mul_f32 v[12:13], v[12:13], v[42:43] op_sel_hi:[1,0]
  v_pk_mul_f32 v[14:15], v[14:15], v[42:43] op_sel_hi:[1,0]
  v_cvt_pk_bf16_f32 v96, v0, v1
  v_cvt_pk_bf16_f32 v97, v2, v3
  v_cvt_pk_bf16_f32 v98, v4, v5
  v_cvt_pk_bf16_f32 v99, v6, v7
  v_cvt_pk_bf16_f32 v100, v8, v9
  v_cvt_pk_bf16_f32 v101, v10, v11
  v_cvt_pk_bf16_f32 v102, v12, v13
  v_cvt_pk_bf16_f32 v103, v14, v15
  buffer_store_dwordx4 v[96:99], v39, s[28:31], s62 offen offset:0 sc1
  buffer_store_dwordx4 v[100:103], v39, s[28:31], s62 offen offset:1024 sc1
  v_pk_fma_f32 v[16:17], v[64:65], v[40:41], v[16:17] op_sel:[0,1,0] neg_lo:[0,1,0] neg_hi:[0,1,0]
  v_pk_fma_f32 v[18:19], v[66:67], v[40:41], v[18:19] op_sel:[0,1,0] neg_lo:[0,1,0] neg_hi:[0,1,0]
  v_pk_fma_f32 v[20:21], v[68:69], v[40:41], v[20:21] op_sel:[0,1,0] neg_lo:[0,1,0] neg_hi:[0,1,0]
  v_pk_fma_f32 v[22:23], v[70:71], v[40:41], v[22:23] op_sel:[0,1,0] neg_lo:[0,1,0] neg_hi:[0,1,0]
  v_pk_fma_f32 v[24:25], v[72:73], v[40:41], v[24:25] op_sel:[0,1,0] neg_lo:[0,1,0] neg_hi:[0,1,0]
  v_pk_fma_f32 v[26:27], v[74:75], v[40:41], v[26:27] op_sel:[0,1,0] neg_lo:[0,1,0] neg_hi:[0,1,0]
  v_pk_fma_f32 v[28:29], v[76:77], v[40:41], v[28:29] op_sel:[0,1,0] neg_lo:[0,1,0] neg_hi:[0,1,0]
  v_pk_fma_f32 v[30:31], v[78:79], v[40:41], v[30:31] op_sel:[0,1,0] neg_lo:[0,1,0] neg_hi:[0,1,0]
  v_pk_mul_f32 v[16:17], v[16:17], v[42:43] op_sel:[0,1]
  v_pk_mul_f32 v[18:19], v[18:19], v[42:43] op_sel:[0,1]
  v_pk_mul_f32 v[20:21], v[20:21], v[42:43] op_sel:[0,1]
  v_pk_mul_f32 v[22:23], v[22:23], v[42:43] op_sel:[0,1]
  v_pk_mul_f32 v[24:25], v[24:25], v[42:43] op_sel:[0,1]
  v_pk_mul_f32 v[26:27], v[26:27], v[42:43] op_sel:[0,1]
  v_pk_mul_f32 v[28:29], v[28:29], v[42:43] op_sel:[0,1]
  v_pk_mul_f32 v[30:31], v[30:31], v[42:43] op_sel:[0,1]
  v_cvt_pk_bf16_f32 v104, v16, v17
  v_cvt_pk_bf16_f32 v105, v18, v19
  v_cvt_pk_bf16_f32 v106, v20, v21
  v_cvt_pk_bf16_f32 v107, v22, v23
  v_cvt_pk_bf16_f32 v108, v24, v25
  v_cvt_pk_bf16_f32 v109, v26, v27
  v_cvt_pk_bf16_f32 v110, v28, v29
  v_cvt_pk_bf16_f32 v111, v30, v31
  buffer_store_dwordx4 v[104:107], v39, s[28:31], s63 offen offset:0 sc1
  buffer_store_dwordx4 v[108:111], v39, s[28:31], s63 offen offset:1024 sc1
  s_branch L_p1_flag
L_p1_v:
  s_waitcnt vmcnt(4)
  s_barrier
  ds_read_b128 v[32:35], v132 offset:0
  ds_read_b64_tr_b16 v[40:41], v140 offset:0
  ds_read_b64_tr_b16 v[42:43], v140 offset:1024
  ds_read_b128 v[36:39], v132 offset:4096
  ds_read_b128 v[44:47], v133 offset:0
  ds_read_b64_tr_b16 v[52:53], v141 offset:0
  ds_read_b64_tr_b16 v[54:55], v141 offset:1024
  ds_read_b128 v[48:51], v133 offset:4096
  ds_read_b128 v[56:59], v134 offset:0
  ds_read_b64_tr_b16 v[64:65], v142 offset:0
  ds_read_b64_tr_b16 v[66:67], v142 offset:1024
  ds_read_b128 v[60:63], v134 offset:4096
  ds_read_b128 v[68:71], v135 offset:0
  ds_read_b64_tr_b16 v[76:77], v143 offset:0
  ds_read_b64_tr_b16 v[78:79], v143 offset:1024
  ds_read_b128 v[72:75], v135 offset:4096
  s_waitcnt lgkmcnt(0)
  s_waitcnt vmcnt(0)
  s_barrier
  v_mfma_f32_32x32x16_bf16 v[0:15], v[32:35], v[40:43], 0
  v_mfma_f32_4x4x4_16b_bf16 v[160:163], v[168:169], v[40:41], 0
  ds_read_b128 v[80:83], v132 offset:32768
  ds_read_b64_tr_b16 v[88:89], v140 offset:32768
  ds_read_b64_tr_b16 v[90:91], v140 offset:33792
  s_add_u32 s66, s3, 2
  s_and_b32 s66, s66, 7
  s_mul_i32 s67, s66, 196608
  s_lshl_b32 s66, s66, 7
  s_add_u32 m0, s52, 65536
  s_nop 0
  buffer_load_dwordx4 v128, s[8:11], s66 offen lds
  v_mfma_f32_32x32x16_bf16 v[16:31], v[36:39], v[40:43], 0
  ds_read_b128 v[84:87], v132 offset:36864
  ds_read_b128 v[92:95], v133 offset:32768
  ds_read_b64_tr_b16 v[100:101], v141 offset:32768
  s_add_u32 m0, s52, 66560
  s_nop 0
  buffer_load_dwordx4 v129, s[8:11], s66 offen lds
  v_mfma_f32_32x32x16_bf16 v[0:15], v[44:47], v[52:55], v[0:15]
  v_mfma_f32_4x4x4_16b_bf16 v[164:167], v[168:169], v[52:53], 0
  ds_read_b64_tr_b16 v[102:103], v141 offset:33792
  ds_read_b128 v[96:99], v133 offset:36864
  ds_read_b128 v[104:107], v134 offset:32768
  s_add_u32 m0, s52, 81920
  s_nop 0
  buffer_load_dwordx4 v130, s[12:15], s67 offen lds
  v_mfma_f32_32x32x16_bf16 v[16:31], v[48:51], v[52:55], v[16:31]
  ds_read_b64_tr_b16 v[112:113], v142 offset:32768
  ds_read_b64_tr_b16 v[114:115], v142 offset:33792
  ds_read_b128 v[108:111], v134 offset:36864
  s_add_u32 m0, s52, 82944
  s_nop 0
  buffer_load_dwordx4 v131, s[12:15], s67 offen lds
  v_mfma_f32_32x32x16_bf16 v[0:15], v[56:59], v[64:67], v[0:15]
  v_mfma_f32_4x4x4_16b_bf16 v[160:163], v[168:169], v[42:43], v[160:163]
  ds_read_b128 v[116:119], v135 offset:32768
  ds_read_b64_tr_b16 v[124:125], v143 offset:32768
  ds_read_b64_tr_b16 v[126:127], v143 offset:33792
  s_add_u32 s66, s3, 3
  s_and_b32 s66, s66, 7
  s_mul_i32 s67, s66, 196608
  s_lshl_b32 s66, s66, 7
  s_add_u32 m0, s52, 98304
  s_nop 0
  buffer_load_dwordx4 v128, s[8:11], s66 offen lds
  v_mfma_f32_32x32x16_bf16 v[16:31], v[60:63], v[64:67], v[16:31]
  ds_read_b128 v[120:123], v135 offset:36864
  s_add_u32 m0, s52, 99328
  s_nop 0
  buffer_load_dwordx4 v129, s[8:11], s66 offen lds
  v_mfma_f32_32x32x16_bf16 v[0:15], v[68:71], v[76:79], v[0:15]
  v_mfma_f32_4x4x4_16b_bf16 v[164:167], v[168:169], v[54:55], v[164:167]
  s_add_u32 m0, s52, 114688
  s_nop 0
  buffer_load_dwordx4 v130, s[12:15], s67 offen lds
  v_mfma_f32_32x32x16_bf16 v[16:31], v[72:75], v[76:79], v[16:31]
  s_add_u32 m0, s52, 115712
  s_nop 0
  buffer_load_dwordx4 v131, s[12:15], s67 offen lds
  s_waitcnt lgkmcnt(0)
  s_waitcnt vmcnt(4)
  s_barrier
  v_mfma_f32_32x32x16_bf16 v[0:15], v[80:83], v[88:91], v[0:15]
  v_mfma_f32_4x4x4_16b_bf16 v[160:163], v[168:169], v[88:89], v[160:163]
  ds_read_b128 v[32:35], v136 offset:0
  ds_read_b64_tr_b16 v[40:41], v144 offset:0
  ds_read_b64_tr_b16 v[42:43], v144 offset:1024
  s_add_u32 s66, s3, 4
  s_and_b32 s66, s66, 7
  s_mul_i32 s67, s66, 196608
  s_lshl_b32 s66, s66, 7
  s_add_u32 m0, s52, 0
  s_nop 0
  buffer_load_dwordx4 v128, s[8:11], s66 offen lds
  v_mfma_f32_32x32x16_bf16 v[16:31], v[84:87], v[88:91], v[16:31]
  ds_read_b128 v[36:39], v136 offset:4096
  ds_read_b128 v[44:47], v137 offset:0
  ds_read_b64_tr_b16 v[52:53], v145 offset:0
  v_mfma_f32_32x32x16_bf16 v[0:15], v[92:95], v[100:103], v[0:15]
  v_mfma_f32_4x4x4_16b_bf16 v[164:167], v[168:169], v[100:101], v[164:167]
  ds_read_b64_tr_b16 v[54:55], v145 offset:1024
  ds_read_b128 v[48:51], v137 offset:4096
  ds_read_b128 v[56:59], v138 offset:0
  s_add_u32 m0, s52, 1024
  s_nop 0
  buffer_load_dwordx4 v129, s[8:11], s66 offen lds
  v_mfma_f32_32x32x16_bf16 v[16:31], v[96:99], v[100:103], v[16:31]
  ds_read_b64_tr_b16 v[64:65], v146 offset:0
  ds_read_b64_tr_b16 v[66:67], v146 offset:1024
  ds_read_b128 v[60:63], v138 offset:4096
  v_mfma_f32_32x32x16_bf16 v[0:15], v[104:107], v[112:115], v[0:15]
  v_mfma_f32_4x4x4_16b_bf16 v[160:163], v[168:169], v[90:91], v[160:163]
  ds_read_b128 v[68:71], v139 offset:0
  ds_read_b64_tr_b16 v[76:77], v147 offset:0
  ds_read_b64_tr_b16 v[78:79], v147 offset:1024
  s_add_u32 m0, s52, 16384
  s_nop 0
  buffer_load_dwordx4 v130, s[12:15], s67 offen lds
  v_mfma_f32_32x32x16_bf16 v[16:31], v[108:111], v[112:115], v[16:31]
  ds_read_b128 v[72:75], v139 offset:4096
  v_mfma_f32_32x32x16_bf16 v[0:15], v[116:119], v[124:127], v[0:15]
  v_mfma_f32_4x4x4_16b_bf16 v[164:167], v[168:169], v[102:103], v[164:167]
  s_add_u32 m0, s52, 17408
  s_nop 0
  buffer_load_dwordx4 v131, s[12:15], s67 offen lds
  v_mfma_f32_32x32x16_bf16 v[16:31], v[120:123], v[124:127], v[16:31]
  s_waitcnt lgkmcnt(0)
  s_waitcnt vmcnt(4)
  s_barrier
  v_mfma_f32_32x32x16_bf16 v[0:15], v[32:35], v[40:43], v[0:15]
  v_mfma_f32_4x4x4_16b_bf16 v[160:163], v[168:169], v[40:41], v[160:163]
  ds_read_b128 v[80:83], v136 offset:32768
  ds_read_b64_tr_b16 v[88:89], v144 offset:32768
  ds_read_b64_tr_b16 v[90:91], v144 offset:33792
  s_add_u32 s66, s3, 5
  s_and_b32 s66, s66, 7
  s_mul_i32 s67, s66, 196608
  s_lshl_b32 s66, s66, 7
  s_add_u32 m0, s52, 32768
  s_nop 0
  buffer_load_dwordx4 v128, s[8:11], s66 offen lds
  v_mfma_f32_32x32x16_bf16 v[16:31], v[36:39], v[40:43], v[16:31]
  ds_read_b128 v[84:87], v136 offset:36864
  ds_read_b128 v[92:95], v137 offset:32768
  ds_read_b64_tr_b16 v[100:101], v145 offset:32768
  v_mfma_f32_32x32x16_bf16 v[0:15], v[44:47], v[52:55], v[0:15]
  v_mfma_f32_4x4x4_16b_bf16 v[164:167], v[168:169], v[52:53], v[164:167]
  ds_read_b64_tr_b16 v[102:103], v145 offset:33792
  ds_read_b128 v[96:99], v137 offset:36864
  ds_read_b128 v[104:107], v138 offset:32768
  s_add_u32 m0, s52, 33792
  s_nop 0
  buffer_load_dwordx4 v129, s[8:11], s66 offen lds
  v_mfma_f32_32x32x16_bf16 v[16:31], v[48:51], v[52:55], v[16:31]
  ds_read_b64_tr_b16 v[112:113], v146 offset:32768
  ds_read_b64_tr_b16 v[114:115], v146 offset:33792
  ds_read_b128 v[108:111], v138 offset:36864
  v_mfma_f32_32x32x16_bf16 v[0:15], v[56:59], v[64:67], v[0:15]
  v_mfma_f32_4x4x4_16b_bf16 v[160:163], v[168:169], v[42:43], v[160:163]
  ds_read_b128 v[116:119], v139 offset:32768
  ds_read_b64_tr_b16 v[124:125], v147 offset:32768
  ds_read_b64_tr_b16 v[126:127], v147 offset:33792
  s_add_u32 m0, s52, 49152
  s_nop 0
  buffer_load_dwordx4 v130, s[12:15], s67 offen lds
  v_mfma_f32_32x32x16_bf16 v[16:31], v[60:63], v[64:67], v[16:31]
  ds_read_b128 v[120:123], v139 offset:36864
  v_mfma_f32_32x32x16_bf16 v[0:15], v[68:71], v[76:79], v[0:15]
  v_mfma_f32_4x4x4_16b_bf16 v[164:167], v[168:169], v[54:55], v[164:167]
  s_add_u32 m0, s52, 50176
  s_nop 0
  buffer_load_dwordx4 v131, s[12:15], s67 offen lds
  v_mfma_f32_32x32x16_bf16 v[16:31], v[72:75], v[76:79], v[16:31]
  v_mov_b32 v170, 0
  buffer_load_dword v171, v170, s[44:47], 0 offen sc1
  s_waitcnt lgkmcnt(0)
  s_waitcnt vmcnt(4)
  s_barrier
  v_mfma_f32_32x32x16_bf16 v[0:15], v[80:83], v[88:91], v[0:15]
  v_mfma_f32_4x4x4_16b_bf16 v[160:163], v[168:169], v[88:89], v[160:163]
  ds_read_b128 v[32:35], v132 offset:0
  ds_read_b64_tr_b16 v[40:41], v140 offset:0
  ds_read_b64_tr_b16 v[42:43], v140 offset:1024
  s_add_u32 s66, s3, 6
  s_and_b32 s66, s66, 7
  s_mul_i32 s67, s66, 196608
  s_lshl_b32 s66, s66, 7
  s_add_u32 m0, s52, 65536
  s_nop 0
  buffer_load_dwordx4 v128, s[8:11], s66 offen lds
  v_mfma_f32_32x32x16_bf16 v[16:31], v[84:87], v[88:91], v[16:31]
  ds_read_b128 v[36:39], v132 offset:4096
  ds_read_b128 v[44:47], v133 offset:0
  ds_read_b64_tr_b16 v[52:53], v141 offset:0
  v_mfma_f32_32x32x16_bf16 v[0:15], v[92:95], v[100:103], v[0:15]
  v_mfma_f32_4x4x4_16b_bf16 v[164:167], v[168:169], v[100:101], v[164:167]
  ds_read_b64_tr_b16 v[54:55], v141 offset:1024
  ds_read_b128 v[48:51], v133 offset:4096
  ds_read_b128 v[56:59], v134 offset:0
  s_add_u32 m0, s52, 66560
  s_nop 0
  buffer_load_dwordx4 v129, s[8:11], s66 offen lds
  v_mfma_f32_32x32x16_bf16 v[16:31], v[96:99], v[100:103], v[16:31]
  ds_read_b64_tr_b16 v[64:65], v142 offset:0
  ds_read_b64_tr_b16 v[66:67], v142 offset:1024
  ds_read_b128 v[60:63], v134 offset:4096
  v_mfma_f32_32x32x16_bf16 v[0:15], v[104:107], v[112:115], v[0:15]
  v_mfma_f32_4x4x4_16b_bf16 v[160:163], v[168:169], v[90:91], v[160:163]
  ds_read_b128 v[68:71], v135 offset:0
  ds_read_b64_tr_b16 v[76:77], v143 offset:0
  ds_read_b64_tr_b16 v[78:79], v143 offset:1024
  s_add_u32 m0, s52, 81920
  s_nop 0
  buffer_load_dwordx4 v130, s[12:15], s67 offen lds
  v_mfma_f32_32x32x16_bf16 v[16:31], v[108:111], v[112:115], v[16:31]
  ds_read_b128 v[72:75], v135 offset:4096
  v_mfma_f32_32x32x16_bf16 v[0:15], v[116:119], v[124:127], v[0:15]
  v_mfma_f32_4x4x4_16b_bf16 v[164:167], v[168:169], v[102:103], v[164:167]
  s_add_u32 m0, s52, 82944
  s_nop 0
  buffer_load_dwordx4 v131, s[12:15], s67 offen lds
  v_mfma_f32_32x32x16_bf16 v[16:31], v[120:123], v[124:127], v[16:31]
  s_waitcnt lgkmcnt(0)
  s_waitcnt vmcnt(4)
  s_barrier
  v_mfma_f32_32x32x16_bf16 v[0:15], v[32:35], v[40:43], v[0:15]
  v_mfma_f32_4x4x4_16b_bf16 v[160:163], v[168:169], v[40:41], v[160:163]
  ds_read_b128 v[80:83], v132 offset:32768
  ds_read_b64_tr_b16 v[88:89], v140 offset:32768
  ds_read_b64_tr_b16 v[90:91], v140 offset:33792
  s_add_u32 s66, s3, 7
  s_and_b32 s66, s66, 7
  s_mul_i32 s67, s66, 196608
  s_lshl_b32 s66, s66, 7
  s_add_u32 m0, s52, 98304
  s_nop 0
  buffer_load_dwordx4 v128, s[8:11], s66 offen lds
  v_mfma_f32_32x32x16_bf16 v[16:31], v[36:39], v[40:43], v[16:31]
  ds_read_b128 v[84:87], v132 offset:36864
  ds_read_b128 v[92:95], v133 offset:32768
  ds_read_b64_tr_b16 v[100:101], v141 offset:32768
  v_mfma_f32_32x32x16_bf16 v[0:15], v[44:47], v[52:55], v[0:15]
  v_mfma_f32_4x4x4_16b_bf16 v[164:167], v[168:169], v[52:53], v[164:167]
  ds_read_b64_tr_b16 v[102:103], v141 offset:33792
  ds_read_b128 v[96:99], v133 offset:36864
  ds_read_b128 v[104:107], v134 offset:32768
  s_add_u32 m0, s52, 99328
  s_nop 0
  buffer_load_dwordx4 v129, s[8:11], s66 offen lds
  v_mfma_f32_32x32x16_bf16 v[16:31], v[48:51], v[52:55], v[16:31]
  ds_read_b64_tr_b16 v[112:113], v142 offset:32768
  ds_read_b64_tr_b16 v[114:115], v142 offset:33792
  ds_read_b128 v[108:111], v134 offset:36864
  v_mfma_f32_32x32x16_bf16 v[0:15], v[56:59], v[64:67], v[0:15]
  v_mfma_f32_4x4x4_16b_bf16 v[160:163], v[168:169], v[42:43], v[160:163]
  ds_read_b128 v[116:119], v135 offset:32768
  ds_read_b64_tr_b16 v[124:125], v143 offset:32768
  ds_read_b64_tr_b16 v[126:127], v143 offset:33792
  s_add_u32 m0, s52, 114688
  s_nop 0
  buffer_load_dwordx4 v130, s[12:15], s67 offen lds
  v_mfma_f32_32x32x16_bf16 v[16:31], v[60:63], v[64:67], v[16:31]
  ds_read_b128 v[120:123], v135 offset:36864
  v_mfma_f32_32x32x16_bf16 v[0:15], v[68:71], v[76:79], v[0:15]
  v_mfma_f32_4x4x4_16b_bf16 v[164:167], v[168:169], v[54:55], v[164:167]
  s_add_u32 m0, s52, 115712
  s_nop 0
  buffer_load_dwordx4 v131, s[12:15], s67 offen lds
  v_mfma_f32_32x32x16_bf16 v[16:31], v[72:75], v[76:79], v[16:31]
  s_waitcnt lgkmcnt(0)
  s_waitcnt vmcnt(4)
  s_barrier
  v_mfma_f32_32x32x16_bf16 v[0:15], v[80:83], v[88:91], v[0:15]
  v_mfma_f32_4x4x4_16b_bf16 v[160:163], v[168:169], v[88:89], v[160:163]
  ds_read_b128 v[32:35], v136 offset:0
  ds_read_b64_tr_b16 v[40:41], v144 offset:0
  ds_read_b64_tr_b16 v[42:43], v144 offset:1024
  buffer_load_dwordx4 v[148:151], v156, s[28:31], 0 offen sc1
  buffer_load_dwordx4 v[152:155], v156, s[28:31], 0 offen offset:512 sc1
  s_add_u32 s63, s101, 0
  s_add_u32 m0, s100, 0
  s_nop 0
  buffer_load_dwordx4 v172, s[16:19], s63 offen lds
  v_mfma_f32_32x32x16_bf16 v[16:31], v[84:87], v[88:91], v[16:31]
  ds_read_b128 v[36:39], v136 offset:4096
  ds_read_b128 v[44:47], v137 offset:0
  ds_read_b64_tr_b16 v[52:53], v145 offset:0
  v_mfma_f32_32x32x16_bf16 v[0:15], v[92:95], v[100:103], v[0:15]
  v_mfma_f32_4x4x4_16b_bf16 v[164:167], v[168:169], v[100:101], v[164:167]
  ds_read_b64_tr_b16 v[54:55], v145 offset:1024
  ds_read_b128 v[48:51], v137 offset:4096
  ds_read_b128 v[56:59], v138 offset:0
  s_add_u32 s63, s101, 16384
  s_add_u32 m0, s100, 2048
  s_nop 0
  buffer_load_dwordx4 v172, s[16:19], s63 offen lds
  v_mfma_f32_32x32x16_bf16 v[16:31], v[96:99], v[100:103], v[16:31]
  ds_read_b64_tr_b16 v[64:65], v146 offset:0
  ds_read_b64_tr_b16 v[66:67], v146 offset:1024
  ds_read_b128 v[60:63], v138 offset:4096
  v_mfma_f32_32x32x16_bf16 v[0:15], v[104:107], v[112:115], v[0:15]
  v_mfma_f32_4x4x4_16b_bf16 v[160:163], v[168:169], v[90:91], v[160:163]
  ds_read_b128 v[68:71], v139 offset:0
  ds_read_b64_tr_b16 v[76:77], v147 offset:0
  ds_read_b64_tr_b16 v[78:79], v147 offset:1024
  s_add_u32 s63, s101, 32768
  s_add_u32 m0, s100, 4096
  s_nop 0
  buffer_load_dwordx4 v172, s[16:19], s63 offen lds
  v_mfma_f32_32x32x16_bf16 v[16:31], v[108:111], v[112:115], v[16:31]
  ds_read_b128 v[72:75], v139 offset:4096
  v_mfma_f32_32x32x16_bf16 v[0:15], v[116:119], v[124:127], v[0:15]
  v_mfma_f32_4x4x4_16b_bf16 v[164:167], v[168:169], v[102:103], v[164:167]
  s_add_u32 s63, s101, 49152
  s_add_u32 m0, s100, 6144
  s_nop 0
  buffer_load_dwordx4 v172, s[16:19], s63 offen lds
  v_mfma_f32_32x32x16_bf16 v[16:31], v[120:123], v[124:127], v[16:31]
  s_waitcnt lgkmcnt(0)
  s_waitcnt vmcnt(6)
  s_barrier
  v_mfma_f32_32x32x16_bf16 v[0:15], v[32:35], v[40:43], v[0:15]
  v_mfma_f32_4x4x4_16b_bf16 v[160:163], v[168:169], v[40:41], v[160:163]
  ds_read_b128 v[80:83], v136 offset:32768
  ds_read_b64_tr_b16 v[88:89], v144 offset:32768
  ds_read_b64_tr_b16 v[90:91], v144 offset:33792
  s_add_u32 s63, s101, 65536
  s_add_u32 m0, s100, 32768
  s_nop 0
  buffer_load_dwordx4 v172, s[16:19], s63 offen lds
  v_mfma_f32_32x32x16_bf16 v[16:31], v[36:39], v[40:43], v[16:31]
  ds_read_b128 v[84:87], v136 offset:36864
  ds_read_b128 v[92:95], v137 offset:32768
  ds_read_b64_tr_b16 v[100:101], v145 offset:32768
  v_mfma_f32_32x32x16_bf16 v[0:15], v[44:47], v[52:55], v[0:15]
  v_mfma_f32_4x4x4_16b_bf16 v[164:167], v[168:169], v[52:53], v[164:167]
  ds_read_b64_tr_b16 v[102:103], v145 offset:33792
  ds_read_b128 v[96:99], v137 offset:36864
  ds_read_b128 v[104:107], v138 offset:32768
  s_add_u32 s63, s101, 81920
  s_add_u32 m0, s100, 34816
  s_nop 0
  buffer_load_dwordx4 v172, s[16:19], s63 offen lds
  v_mfma_f32_32x32x16_bf16 v[16:31], v[48:51], v[52:55], v[16:31]
  ds_read_b64_tr_b16 v[112:113], v146 offset:32768
  ds_read_b64_tr_b16 v[114:115], v146 offset:33792
  ds_read_b128 v[108:111], v138 offset:36864
  v_mfma_f32_32x32x16_bf16 v[0:15], v[56:59], v[64:67], v[0:15]
  v_mfma_f32_4x4x4_16b_bf16 v[160:163], v[168:169], v[42:43], v[160:163]
  ds_read_b128 v[116:119], v139 offset:32768
  ds_read_b64_tr_b16 v[124:125], v147 offset:32768
  ds_read_b64_tr_b16 v[126:127], v147 offset:33792
  s_add_u32 s63, s101, 98304
  s_add_u32 m0, s100, 36864
  s_nop 0
  buffer_load_dwordx4 v172, s[16:19], s63 offen lds
  v_mfma_f32_32x32x16_bf16 v[16:31], v[60:63], v[64:67], v[16:31]
  ds_read_b128 v[120:123], v139 offset:36864
  v_mfma_f32_32x32x16_bf16 v[0:15], v[68:71], v[76:79], v[0:15]
  v_mfma_f32_4x4x4_16b_bf16 v[164:167], v[168:169], v[54:55], v[164:167]
  s_add_u32 s63, s101, 114688
  s_add_u32 m0, s100, 38912
  s_nop 0
  buffer_load_dwordx4 v172, s[16:19], s63 offen lds
  v_mfma_f32_32x32x16_bf16 v[16:31], v[72:75], v[76:79], v[16:31]
  s_waitcnt lgkmcnt(0)
  v_mfma_f32_32x32x16_bf16 v[0:15], v[80:83], v[88:91], v[0:15]
  v_mfma_f32_4x4x4_16b_bf16 v[160:163], v[168:169], v[88:89], v[160:163]
  v_mfma_f32_32x32x16_bf16 v[16:31], v[84:87], v[88:91], v[16:31]
  v_mfma_f32_4x4x4_16b_bf16 v[164:167], v[168:169], v[100:101], v[164:167]
  v_mfma_f32_32x32x16_bf16 v[0:15], v[92:95], v[100:103], v[0:15]
  v_mfma_f32_4x4x4_16b_bf16 v[160:163], v[168:169], v[90:91], v[160:163]
  v_mfma_f32_32x32x16_bf16 v[16:31], v[96:99], v[100:103], v[16:31]
  v_mfma_f32_4x4x4_16b_bf16 v[164:167], v[168:169], v[102:103], v[164:167]
  v_mfma_f32_32x32x16_bf16 v[0:15], v[104:107], v[112:115], v[0:15]
  v_and_b32 v33, 31, v186
  s_lshl_b32 s61, s54, 7
  s_add_u32 s61, s61, 135168
  v_lshl_add_u32 v36, v33, 2, s61
  v_mfma_f32_32x32x16_bf16 v[16:31], v[108:111], v[112:115], v[16:31]
  s_lshl_b32 s62, s53, 9
  v_add_u32 v37, s62, v36
  v_add_f32 v160, v160, v164
  v_mov_b32 v34, v160
  v_mfma_f32_32x32x16_bf16 v[0:15], v[116:119], v[124:127], v[0:15]
  s_nop 1
  v_permlane32_swap_b32 v34, v160
  s_nop 1
  v_add_f32 v160, v160, v34
  v_mfma_f32_32x32x16_bf16 v[16:31], v[120:123], v[124:127], v[16:31]
  ds_write_b32 v37, v160
  s_mov_b32 s55, 0x40000
na_5:
  v_readfirstlane_b32 s51, v171
  s_cmp_lg_u32 s51, 0
  s_cbranch_scc1 nad_6
  s_sleep 16
  buffer_load_dword v171, v170, s[44:47], 0 offen sc1
  s_waitcnt vmcnt(0)
  s_sub_u32 s55, s55, 1
  s_cmp_lg_u32 s55, 0
  s_cbranch_scc1 na_5
  s_mov_b32 s99, 1
nad_6:
  s_waitcnt vmcnt(0) lgkmcnt(0)
  s_barrier
  ds_read_b32 v60, v36
  ds_read_b32 v61, v36 offset:512
  s_mov_b32 s55, 0x40000
xs_7:
  v_cmp_ne_u32 vcc, s51, v150
  v_cmp_ne_u32 s[4:5], s51, v154
  s_nop 1
  s_or_b64 vcc, vcc, s[4:5]
  s_cbranch_vccz xsd_8
  s_sleep 4
  buffer_load_dwordx4 v[148:151], v156, s[28:31], 0 offen sc1
  buffer_load_dwordx4 v[152:155], v156, s[28:31], 0 offen offset:512 sc1
  s_waitcnt vmcnt(0)
  s_sub_u32 s55, s55, 1
  s_cmp_lg_u32 s55, 0
  s_cbranch_scc1 xs_7
  s_mov_b32 s99, 1
xsd_8:
  v_mov_b32 v40, v148
  v_mov_b32 v41, v152
  v_mov_b32 v42, v149
  v_mov_b32 v43, v153
  s_lshl_b32 s61, s48, 9
  s_add_u32 s61, s61, 136192
  v_lshl_add_u32 v38, v33, 2, s61
  ds_write_b32 v38, v40
  ds_write_b32 v38, v41 offset:128
  ds_write_b32 v38, v42 offset:256
  ds_write_b32 v38, v43 offset:384
  v_lshrrev_b32 v38, 5, v186
  v_lshl_add_u32 v38, v38, 4, s61
  s_waitcnt lgkmcnt(0)
  v_add_f32 v60, v60, v61
  ds_read_b128 v[64:67], v38 offset:0
  ds_read_b128 v[80:83], v38 offset:256
  ds_read_b128 v[68:71], v38 offset:32
  ds_read_b128 v[84:87], v38 offset:288
  ds_read_b128 v[72:75], v38 offset:64
  ds_read_b128 v[88:91], v38 offset:320
  ds_read_b128 v[76:79], v38 offset:96
  ds_read_b128 v[92:95], v38 offset:352
  ds_read_b128 v[96:99], v38 offset:128
  ds_read_b128 v[112:115], v38 offset:384
  ds_read_b128 v[100:103], v38 offset:160
  ds_read_b128 v[116:119], v38 offset:416
  ds_read_b128 v[104:107], v38 offset:192
  ds_read_b128 v[120:123], v38 offset:448
  ds_read_b128 v[108:111], v38 offset:224
  ds_read_b128 v[124:127], v38 offset:480
  s_and_b32 s62, s65, 3
  s_lshl_b32 s62, s62, 3
  s_lshl_b32 s61, s54, 1
  s_add_u32 s62, s62, s61
  s_lshl_b32 s61, s64, 1
  s_add_u32 s61, s61, s53
  s_lshl_b32 s61, s61, 6
  s_add_u32 s62, s62, s61
  s_lshl_b32 s62, s62, 10
  s_add_u32 s62, s62, 5242880
  s_add_u32 s63, s62, 32768
  v_and_b32 v39, 15, v186
  v_lshlrev_b32 v39, 4, v39
  v_bfe_u32 v37, v186, 4, 1
  v_lshl_add_u32 v39, v37, 10, v39
  v_lshrrev_b32 v37, 5, v186
  v_lshl_add_u32 v39, v37, 8, v39
  s_waitcnt lgkmcnt(8)
  v_pk_fma_f32 v[0:1], v[64:65], v[60:61], v[0:1] op_sel_hi:[1,0,1] neg_lo:[0,1,0] neg_hi:[0,1,0]
  v_pk_fma_f32 v[2:3], v[66:67], v[60:61], v[2:3] op_sel_hi:[1,0,1] neg_lo:[0,1,0] neg_hi:[0,1,0]
  v_pk_fma_f32 v[4:5], v[68:69], v[60:61], v[4:5] op_sel_hi:[1,0,1] neg_lo:[0,1,0] neg_hi:[0,1,0]
  v_pk_fma_f32 v[6:7], v[70:71], v[60:61], v[6:7] op_sel_hi:[1,0,1] neg_lo:[0,1,0] neg_hi:[0,1,0]
  v_pk_fma_f32 v[8:9], v[72:73], v[60:61], v[8:9] op_sel_hi:[1,0,1] neg_lo:[0,1,0] neg_hi:[0,1,0]
  v_pk_fma_f32 v[10:11], v[74:75], v[60:61], v[10:11] op_sel_hi:[1,0,1] neg_lo:[0,1,0] neg_hi:[0,1,0]
  v_pk_fma_f32 v[12:13], v[76:77], v[60:61], v[12:13] op_sel_hi:[1,0,1] neg_lo:[0,1,0] neg_hi:[0,1,0]
  v_pk_fma_f32 v[14:15], v[78:79], v[60:61], v[14:15] op_sel_hi:[1,0,1] neg_lo:[0,1,0] neg_hi:[0,1,0]
  v_pk_mul_f32 v[0:1], v[0:1], v[80:81]
  v_pk_mul_f32 v[2:3], v[2:3], v[82:83]
  v_pk_mul_f32 v[4:5], v[4:5], v[84:85]
  v_pk_mul_f32 v[6:7], v[6:7], v[86:87]
  v_pk_mul_f32 v[8:9], v[8:9], v[88:89]
  v_pk_mul_f32 v[10:11], v[10:11], v[90:91]
  v_pk_mul_f32 v[12:13], v[12:13], v[92:93]
  v_pk_mul_f32 v[14:15], v[14:15], v[94:95]
  v_cvt_pk_bf16_f32 v154, v0, v1
  v_cvt_pk_bf16_f32 v155, v2, v3
  v_cvt_pk_bf16_f32 v156, v4, v5
  v_cvt_pk_bf16_f32 v157, v6, v7
  v_cvt_pk_bf16_f32 v158, v8, v9
  v_cvt_pk_bf16_f32 v159, v10, v11
  v_cvt_pk_bf16_f32 v160, v12, v13
  v_cvt_pk_bf16_f32 v161, v14, v15
  buffer_store_dwordx4 v[154:157], v39, s[28:31], s62 offen offset:0 sc1
  buffer_store_dwordx4 v[158:161], v39, s[28:31], s62 offen offset:512 sc1
  s_waitcnt lgkmcnt(0)
  v_pk_fma_f32 v[16:17], v[96:97], v[60:61], v[16:17] op_sel_hi:[1,0,1] neg_lo:[0,1,0] neg_hi:[0,1,0]
  v_pk_fma_f32 v[18:19], v[98:99], v[60:61], v[18:19] op_sel_hi:[1,0,1] neg_lo:[0,1,0] neg_hi:[0,1,0]
  v_pk_fma_f32 v[20:21], v[100:101], v[60:61], v[20:21] op_sel_hi:[1,0,1] neg_lo:[0,1,0] neg_hi:[0,1,0]
  v_pk_fma_f32 v[22:23], v[102:103], v[60:61], v[22:23] op_sel_hi:[1,0,1] neg_lo:[0,1,0] neg_hi:[0,1,0]
  v_pk_fma_f32 v[24:25], v[104:105], v[60:61], v[24:25] op_sel_hi:[1,0,1] neg_lo:[0,1,0] neg_hi:[0,1,0]
  v_pk_fma_f32 v[26:27], v[106:107], v[60:61], v[26:27] op_sel_hi:[1,0,1] neg_lo:[0,1,0] neg_hi:[0,1,0]
  v_pk_fma_f32 v[28:29], v[108:109], v[60:61], v[28:29] op_sel_hi:[1,0,1] neg_lo:[0,1,0] neg_hi:[0,1,0]
  v_pk_fma_f32 v[30:31], v[110:111], v[60:61], v[30:31] op_sel_hi:[1,0,1] neg_lo:[0,1,0] neg_hi:[0,1,0]
  v_pk_mul_f32 v[16:17], v[16:17], v[112:113]
  v_pk_mul_f32 v[18:19], v[18:19], v[114:115]
  v_pk_mul_f32 v[20:21], v[20:21], v[116:117]
  v_pk_mul_f32 v[22:23], v[22:23], v[118:119]
  v_pk_mul_f32 v[24:25], v[24:25], v[120:121]
  v_pk_mul_f32 v[26:27], v[26:27], v[122:123]
  v_pk_mul_f32 v[28:29], v[28:29], v[124:125]
  v_pk_mul_f32 v[30:31], v[30:31], v[126:127]
  v_cvt_pk_bf16_f32 v162, v16, v17
  v_cvt_pk_bf16_f32 v163, v18, v19
  v_cvt_pk_bf16_f32 v164, v20, v21
  v_cvt_pk_bf16_f32 v165, v22, v23
  v_cvt_pk_bf16_f32 v166, v24, v25
  v_cvt_pk_bf16_f32 v167, v26, v27
  v_cvt_pk_bf16_f32 v168, v28, v29
  v_cvt_pk_bf16_f32 v169, v30, v31
  buffer_store_dwordx4 v[162:165], v39, s[28:31], s63 offen offset:0 sc1
  buffer_store_dwordx4 v[166:169], v39, s[28:31], s63 offen offset:512 sc1
L_p1_flag:
  s_lshl_b32 s62, s65, 4
  s_add_u32 s62, s62, s64
  s_lshl_b32 s62, s62, 7
  s_add_u32 s62, s62, 32768
  s_branch L_p1_done
L_p1_idle:
  s_lshr_b32 s56, s50, 3
  s_lshl_b32 s63, s49, 2
  s_add_u32 s56, s56, s63
  s_and_b32 s57, s50, 7
  s_cmp_ge_u32 s50, 14
  s_cselect_b32 s58, 1, 0
  s_mul_i32 s63, s58, 14
  s_sub_u32 s59, s50, s63
  s_lshl_b32 s63, s49, 1
  s_add_u32 s58, s58, s63
  v_lshrrev_b32 v32, 3, v186
  v_bfe_u32 v33, v186, 4, 1
  v_lshlrev_b32 v33, 2, v33
  v_and_b32 v34, 7, v186
  v_xor_b32 v33, v33, v34
  s_lshl_b32 s63, s53, 3
  v_add_u32 v32, s63, v32
  v_lshlrev_b32 v32, 10, v32
  v_lshl_add_u32 v32, v33, 4, v32
  s_lshl_b32 s63, s57, 7
  v_add_u32 v172, s63, v32
  s_lshl_b32 s100, s54, 13
  s_lshl_b32 s63, s53, 10
  s_add_u32 s100, s100, s63
  s_lshl_b32 s101, s54, 17
  s_lshl_b32 s7, s58, 2
  s_add_u32 s7, s7, s59
  v_lshrrev_b32 v32, 4, v186
  v_and_b32 v33, 15, v186
  v_lshlrev_b32 v34, 2, v32
  v_xor_b32 v33, v33, v34
  s_lshl_b32 s63, s48, 2
  v_add_u32 v32, s63, v32
  v_mul_u32_u24 v32, 3584, v32
  v_lshl_add_u32 v32, v33, 4, v32
  s_lshl_b32 s63, s59, 8
  v_add_u32 v173, s63, v32
  s_lshl_b32 s6, s48, 10
  s_cmp_lt_u32 s50, 28
  s_cbranch_scc1 L_w1ok2
  v_mov_b32 v173, 0x7ff00000
L_w1ok2:
  v_bfe_u32 v32, v186, 2, 2
  v_lshrrev_b32 v33, 5, v186
  v_lshl_add_u32 v33, v33, 2, v32
  v_lshlrev_b32 v33, 7, v33
  v_bfe_u32 v34, v186, 4, 1
  v_add_u32 v34, s54, v34
  v_and_b32 v34, 3, v34
  v_lshlrev_b32 v34, 1, v34
  v_bfe_u32 v35, v186, 1, 1
  v_add_u32 v34, v34, v35
  v_lshrrev_b32 v35, 1, v32
  v_lshlrev_b32 v35, 2, v35
  v_xor_b32 v34, v34, v35
  v_lshl_add_u32 v33, v34, 4, v33
  v_and_b32 v35, 1, v186
  v_lshl_add_u32 v174, v35, 3, v33
  v_xor_b32 v175, 64, v174
  s_lshl_b32 s62, s54, 13
  v_add_u32 v176, s62, v174
  v_add_u32 v177, s62, v175
  s_sub_u32 s62, s50, 24
  s_lshl_b32 s63, s49, 3
  s_add_u32 s62, s62, s63
  s_lshl_b32 s62, s62, 3
  s_add_u32 s62, s62, s48
  s_lshl_b32 s62, s62, 2
  v_lshrrev_b32 v1, 4, v186
  v_add_u32 v1, s62, v1
  v_and_b32 v2, 15, v186
  v_lshlrev_b32 v2, 4, v2
  v_lshl_add_u32 v2, v1, 10, v2
  v_lshlrev_b32 v1, 4, v1
  v_mov_b32 v4, 0
  v_mov_b32 v5, 0
  buffer_load_dwordx4 v[8:11], v2, s[8:11], 0 offen offset:0
  buffer_load_dwordx4 v[12:15], v2, s[8:11], 0 offen offset:256
  buffer_load_dwordx4 v[16:19], v2, s[8:11], 0 offen offset:512
  buffer_load_dwordx4 v[20:23], v2, s[8:11], 0 offen offset:768
  v_mov_b32 v170, 0
  s_cmp_lg_u32 s48, 0
  s_cbranch_scc1 nl_9
  buffer_load_dword v171, v170, s[44:47], 0 offen sc1
nl_9:
  s_waitcnt vmcnt(0)
  s_cmp_lg_u32 s48, 0
  s_cbranch_scc1 nce_12
  s_mov_b32 s55, 0x40000
nc_10:
  v_readfirstlane_b32 s51, v171
  s_cmp_lg_u32 s51, 0
  s_cbranch_scc1 ncd_11
  s_sleep 16
  buffer_load_dword v171, v170, s[44:47], 0 offen sc1
  s_waitcnt vmcnt(0)
  s_sub_u32 s55, s55, 1
  s_cmp_lg_u32 s55, 0
  s_cbranch_scc1 nc_10
  s_mov_b32 s99, 1
ncd_11:
  v_mov_b32 v170, 163836
  ds_write_b32 v170, v171
nce_12:
  v_dot2_f32_bf16 v4, v8, s60, v4
  v_dot2_f32_bf16 v5, v8, v8, v5
  v_dot2_f32_bf16 v4, v9, s60, v4
  v_dot2_f32_bf16 v5, v9, v9, v5
  v_dot2_f32_bf16 v4, v10, s60, v4
  v_dot2_f32_bf16 v5, v10, v10, v5
  v_dot2_f32_bf16 v4, v11, s60, v4
  v_dot2_f32_bf16 v5, v11, v11, v5
  v_dot2_f32_bf16 v4, v12, s60, v4
  v_dot2_f32_bf16 v5, v12, v12, v5
  v_dot2_f32_bf16 v4, v13, s60, v4
  v_dot2_f32_bf16 v5, v13, v13, v5
  v_dot2_f32_bf16 v4, v14, s60, v4
  v_dot2_f32_bf16 v5, v14, v14, v5
  v_dot2_f32_bf16 v4, v15, s60, v4
  v_dot2_f32_bf16 v5, v15, v15, v5
  v_dot2_f32_bf16 v4, v16, s60, v4
  v_dot2_f32_bf16 v5, v16, v16, v5
  v_dot2_f32_bf16 v4, v17, s60, v4
  v_dot2_f32_bf16 v5, v17, v17, v5
  v_dot2_f32_bf16 v4, v18, s60, v4
  v_dot2_f32_bf16 v5, v18, v18, v5
  v_dot2_f32_bf16 v4, v19, s60, v4
  v_dot2_f32_bf16 v5, v19, v19, v5
  v_dot2_f32_bf16 v4, v20, s60, v4
  v_dot2_f32_bf16 v5, v20, v20, v5
  v_dot2_f32_bf16 v4, v21, s60, v4
  v_dot2_f32_bf16 v5, v21, v21, v5
  v_dot2_f32_bf16 v4, v22, s60, v4
  v_dot2_f32_bf16 v5, v22, v22, v5
  v_dot2_f32_bf16 v4, v23, s60, v4
  v_dot2_f32_bf16 v5, v23, v23, v5
  s_waitcnt lgkmcnt(0)
  s_barrier
  v_mov_b32 v170, 163836
  ds_read_b32 v171, v170
  s_waitcnt lgkmcnt(0)
  v_readfirstlane_b32 s51, v171
  v_add_f32_dpp v4, v4, v4 row_ror:8 row_mask:0xf bank_mask:0xf
  v_add_f32_dpp v5, v5, v5 row_ror:8 row_mask:0xf bank_mask:0xf
  s_nop 0
  v_add_f32_dpp v4, v4, v4 row_ror:4 row_mask:0xf bank_mask:0xf
  v_add_f32_dpp v5, v5, v5 row_ror:4 row_mask:0xf bank_mask:0xf
  s_nop 0
  v_add_f32_dpp v4, v4, v4 row_ror:2 row_mask:0xf bank_mask:0xf
  v_add_f32_dpp v5, v5, v5 row_ror:2 row_mask:0xf bank_mask:0xf
  s_nop 0
  v_add_f32_dpp v4, v4, v4 row_ror:1 row_mask:0xf bank_mask:0xf
  v_add_f32_dpp v5, v5, v5 row_ror:1 row_mask:0xf bank_mask:0xf
  s_nop 0
  v_mul_f32 v4, 0x3b000000, v4
  v_mul_f32 v5, 0x3b000000, v5
  v_fma_f32 v5, -v4, v4, v5
  v_max_f32 v5, 0, v5
  v_add_f32 v5, 0x3727c5ac, v5
  v_rsq_f32 v5, v5
  v_mov_b32 v6, s51
  v_mov_b32 v7, s51
  s_mov_b32 s61, 196608
  s_mov_b32 exec_lo, 0x00010001
  s_mov_b32 exec_hi, 0x00010001
  buffer_store_dwordx4 v[4:7], v1, s[28:31], s61 offen sc1
  s_mov_b64 exec, -1
  s_sub_u32 s62, s50, 24
  s_lshl_b32 s63, s62, 3
  s_add_u32 s63, s63, s49
  s_lshl_b32 s63, s63, 3
  s_add_u32 s63, s63, s48
  v_lshlrev_b32 v32, 7, v186
  s_lshl_b32 s61, s63, 13
  s_cmp_lt_u32 s63, 224
  s_cbranch_scc0 L_wm1
  buffer_load_dword v33, v32, s[20:23], s61 offen
  s_branch L_wm3
L_wm1:
  s_sub_u32 s61, s61, 1835008
  s_cmp_lt_u32 s63, 448
  s_cbranch_scc0 L_wm2
  buffer_load_dword v33, v32, s[24:27], s61 offen
  s_branch L_wm3
L_wm2:
  s_sub_u32 s61, s61, 1835008
  buffer_load_dword v33, v32, s[16:19], s61 offen
L_wm3:
  s_waitcnt vmcnt(0)
  s_lshl_b32 s63, s62, 3
  s_add_u32 s63, s63, s48
  s_lshl_b32 s63, s63, 13
  buffer_load_dword v33, v32, s[16:19], s63 offen
  s_mul_i32 s62, s62, 28
  s_lshl_b32 s63, s48, 2
  s_min_u32 s63, s63, 24
  s_add_u32 s62, s62, s63
  s_lshl_b32 s62, s62, 13
  s_add_u32 s63, s101, 0
  s_add_u32 m0, s100, 0
  s_nop 0
  buffer_load_dwordx4 v172, s[16:19], s63 offen lds
  s_add_u32 s63, s101, 16384
  s_add_u32 m0, s100, 2048
  s_nop 0
  buffer_load_dwordx4 v172, s[16:19], s63 offen lds
  s_add_u32 s63, s101, 32768
  s_add_u32 m0, s100, 4096
  s_nop 0
  buffer_load_dwordx4 v172, s[16:19], s63 offen lds
  s_add_u32 s63, s101, 49152
  s_add_u32 m0, s100, 6144
  s_nop 0
  buffer_load_dwordx4 v172, s[16:19], s63 offen lds
  s_add_u32 s63, s101, 65536
  s_add_u32 m0, s100, 32768
  s_nop 0
  buffer_load_dwordx4 v172, s[16:19], s63 offen lds
  s_add_u32 s63, s101, 81920
  s_add_u32 m0, s100, 34816
  s_nop 0
  buffer_load_dwordx4 v172, s[16:19], s63 offen lds
  s_add_u32 s63, s101, 98304
  s_add_u32 m0, s100, 36864
  s_nop 0
  buffer_load_dwordx4 v172, s[16:19], s63 offen lds
  s_add_u32 s63, s101, 114688
  s_add_u32 m0, s100, 38912
  s_nop 0
  buffer_load_dwordx4 v172, s[16:19], s63 offen lds
  buffer_load_dword v33, v32, s[20:23], s62 offen
  s_add_u32 s62, s62, 8192
  s_waitcnt vmcnt(0)
  s_barrier
  s_mov_b32 s62, 0
L_p1_done:
  ds_read_b64_tr_b16 v[192:193], v176 offset:0
  ds_read_b64_tr_b16 v[194:195], v176 offset:1024
  ds_read_b64_tr_b16 v[196:197], v177 offset:0
  ds_read_b64_tr_b16 v[198:199], v177 offset:1024
  ds_read_b64_tr_b16 v[200:201], v176 offset:2048
  ds_read_b64_tr_b16 v[202:203], v176 offset:3072
  ds_read_b64_tr_b16 v[204:205], v177 offset:2048
  ds_read_b64_tr_b16 v[206:207], v177 offset:3072
  ds_read_b64_tr_b16 v[208:209], v176 offset:4096
  ds_read_b64_tr_b16 v[210:211], v176 offset:5120
  ds_read_b64_tr_b16 v[212:213], v177 offset:4096
  ds_read_b64_tr_b16 v[214:215], v177 offset:5120
  ds_read_b64_tr_b16 v[216:217], v176 offset:6144
  ds_read_b64_tr_b16 v[218:219], v176 offset:7168
  ds_read_b64_tr_b16 v[220:221], v177 offset:6144
  ds_read_b64_tr_b16 v[222:223], v177 offset:7168
  ds_read_b64_tr_b16 v[224:225], v176 offset:32768
  ds_read_b64_tr_b16 v[226:227], v176 offset:33792
  ds_read_b64_tr_b16 v[228:229], v177 offset:32768
  ds_read_b64_tr_b16 v[230:231], v177 offset:33792
  ds_read_b64_tr_b16 v[232:233], v176 offset:34816
  ds_read_b64_tr_b16 v[234:235], v176 offset:35840
  ds_read_b64_tr_b16 v[236:237], v177 offset:34816
  ds_read_b64_tr_b16 v[238:239], v177 offset:35840
  ds_read_b64_tr_b16 v[240:241], v176 offset:36864
  ds_read_b64_tr_b16 v[242:243], v176 offset:37888
  ds_read_b64_tr_b16 v[244:245], v177 offset:36864
  ds_read_b64_tr_b16 v[246:247], v177 offset:37888
  ds_read_b64_tr_b16 v[248:249], v176 offset:38912
  ds_read_b64_tr_b16 v[250:251], v176 offset:39936
  ds_read_b64_tr_b16 v[252:253], v177 offset:38912
  ds_read_b64_tr_b16 v[254:255], v177 offset:39936
  s_waitcnt lgkmcnt(0)
  s_waitcnt vmcnt(0)
  s_barrier
  s_cmp_lg_u32 s48, 0
  s_cbranch_scc1 sf_13
  s_cmp_eq_u32 s62, 0
  s_cbranch_scc1 sf_13
  v_mov_b32 v32, s51
  v_mov_b32 v33, 0
  s_mov_b64 exec, 1
  buffer_store_dword v32, v33, s[28:31], s62 offen sc1
  s_mov_b64 exec, -1
sf_13:
  s_lshl_b32 s63, s7, 1
  s_add_u32 s63, s63, 0
  s_and_b32 s63, s63, 15
  s_mul_i32 s63, s63, 114688
  s_add_u32 m0, s6, 0
  s_nop 0
  buffer_load_dwordx4 v173, s[20:23], s63 offen lds
  s_lshl_b32 s63, s7, 1
  s_add_u32 s63, s63, 1
  s_and_b32 s63, s63, 15
  s_mul_i32 s63, s63, 114688
  s_add_u32 m0, s6, 8192
  s_nop 0
  buffer_load_dwordx4 v173, s[20:23], s63 offen lds
  s_lshl_b32 s63, s7, 1
  s_add_u32 s63, s63, 2
  s_and_b32 s63, s63, 15
  s_mul_i32 s63, s63, 114688
  s_add_u32 m0, s6, 16384
  s_nop 0
  buffer_load_dwordx4 v173, s[20:23], s63 offen lds
  s_lshl_b32 s63, s7, 1
  s_add_u32 s63, s63, 3
  s_and_b32 s63, s63, 15
  s_mul_i32 s63, s63, 114688
  s_add_u32 m0, s6, 24576
  s_nop 0
  buffer_load_dwordx4 v173, s[20:23], s63 offen lds
  s_lshl_b32 s63, s7, 1
  s_add_u32 s63, s63, 4
  s_and_b32 s63, s63, 15
  s_mul_i32 s63, s63, 114688
  s_add_u32 m0, s6, 32768
  s_nop 0
  buffer_load_dwordx4 v173, s[20:23], s63 offen lds
  s_lshl_b32 s63, s7, 1
  s_add_u32 s63, s63, 5
  s_and_b32 s63, s63, 15
  s_mul_i32 s63, s63, 114688
  s_add_u32 m0, s6, 40960
  s_nop 0
  buffer_load_dwordx4 v173, s[20:23], s63 offen lds
  s_lshl_b32 s63, s7, 1
  s_add_u32 s63, s63, 6
  s_and_b32 s63, s63, 15
  s_mul_i32 s63, s63, 114688
  s_add_u32 m0, s6, 49152
  s_nop 0
  buffer_load_dwordx4 v173, s[20:23], s63 offen lds
  s_lshl_b32 s63, s7, 1
  s_add_u32 s63, s63, 7
  s_and_b32 s63, s63, 15
  s_mul_i32 s63, s63, 114688
  s_add_u32 m0, s6, 57344
  s_nop 0
  buffer_load_dwordx4 v173, s[20:23], s63 offen lds
  s_lshl_b32 s63, s7, 1
  s_add_u32 s63, s63, 8
  s_and_b32 s63, s63, 15
  s_mul_i32 s63, s63, 114688
  s_add_u32 m0, s6, 65536
  s_nop 0
  buffer_load_dwordx4 v173, s[20:23], s63 offen lds
  s_lshl_b32 s63, s7, 1
  s_add_u32 s63, s63, 9
  s_and_b32 s63, s63, 15
  s_mul_i32 s63, s63, 114688
  s_add_u32 m0, s6, 73728
  s_nop 0
  buffer_load_dwordx4 v173, s[20:23], s63 offen lds
  s_lshl_b32 s63, s7, 1
  s_add_u32 s63, s63, 10
  s_and_b32 s63, s63, 15
  s_mul_i32 s63, s63, 114688
  s_add_u32 m0, s6, 81920
  s_nop 0
  buffer_load_dwordx4 v173, s[20:23], s63 offen lds
  s_lshl_b32 s63, s7, 1
  s_add_u32 s63, s63, 11
  s_and_b32 s63, s63, 15
  s_mul_i32 s63, s63, 114688
  s_add_u32 m0, s6, 90112
  s_nop 0
  buffer_load_dwordx4 v173, s[20:23], s63 offen lds
  s_lshl_b32 s63, s7, 1
  s_add_u32 s63, s63, 12
  s_and_b32 s63, s63, 15
  s_mul_i32 s63, s63, 114688
  s_add_u32 m0, s6, 98304
  s_nop 0
  buffer_load_dwordx4 v173, s[20:23], s63 offen lds
  s_lshl_b32 s63, s7, 1
  s_add_u32 s63, s63, 13
  s_and_b32 s63, s63, 15
  s_mul_i32 s63, s63, 114688
  s_add_u32 m0, s6, 106496
  s_nop 0
  buffer_load_dwordx4 v173, s[20:23], s63 offen lds
  s_lshl_b32 s63, s7, 1
  s_add_u32 s63, s63, 14
  s_and_b32 s63, s63, 15
  s_mul_i32 s63, s63, 114688
  s_add_u32 m0, s6, 114688
  s_nop 0
  buffer_load_dwordx4 v173, s[20:23], s63 offen lds
  s_lshl_b32 s63, s7, 1
  s_add_u32 s63, s63, 15
  s_and_b32 s63, s63, 15
  s_mul_i32 s63, s63, 114688
  s_add_u32 m0, s6, 122880
  s_nop 0
  buffer_load_dwordx4 v173, s[20:23], s63 offen lds
  v_and_b32 v32, 31, v186
  s_lshl_b32 s62, s56, 1
  s_add_u32 s62, s62, s53
  s_lshl_b32 s62, s62, 5
  v_add_u32 v32, s62, v32
  v_lshlrev_b32 v32, 10, v32
  v_lshrrev_b32 v33, 5, v186
  v_lshl_add_u32 v32, v33, 3, v32
  s_lshl_b32 s62, s57, 2
  s_add_u32 s62, s62, s54
  s_lshl_b32 s62, s62, 5
  buffer_load_dwordx2 v[188:189], v32, s[8:11], s62 offen
  buffer_load_dwordx2 v[190:191], v32, s[8:11], s62 offen offset:16
  v_and_b32 v168, 31, v186
  v_lshrrev_b32 v169, 5, v186
  v_lshlrev_b32 v169, 2, v169
  v_sub_u32 v168, v168, v169
  v_cmp_le_i32 s[64:65], 0, v168
  v_cmp_le_i32 s[66:67], 1, v168
  v_cmp_le_i32 s[68:69], 2, v168
  v_cmp_le_i32 s[70:71], 3, v168
  v_cmp_le_i32 s[72:73], 8, v168
  v_cmp_le_i32 s[74:75], 9, v168
  v_cmp_le_i32 s[76:77], 10, v168
  v_cmp_le_i32 s[78:79], 11, v168
  v_cmp_le_i32 s[80:81], 16, v168
  v_cmp_le_i32 s[82:83], 17, v168
  v_cmp_le_i32 s[84:85], 18, v168
  v_cmp_le_i32 s[86:87], 19, v168
  v_cmp_le_i32 s[88:89], 24, v168
  v_cmp_le_i32 s[90:91], 25, v168
  v_cmp_le_i32 s[92:93], 26, v168
  v_cmp_le_i32 s[94:95], 27, v168
  v_mov_b32 v169, 0xffff
  v_mov_b32 v170, 0xffff0000
  v_cndmask_b32 v160, 0, v169, s[64:65]
  v_cndmask_b32 v171, 0, v170, s[66:67]
  v_or_b32 v160, v160, v171
  v_cndmask_b32 v161, 0, v169, s[68:69]
  v_cndmask_b32 v171, 0, v170, s[70:71]
  v_or_b32 v161, v161, v171
  v_cndmask_b32 v162, 0, v169, s[72:73]
  v_cndmask_b32 v171, 0, v170, s[74:75]
  v_or_b32 v162, v162, v171
  v_cndmask_b32 v163, 0, v169, s[76:77]
  v_cndmask_b32 v171, 0, v170, s[78:79]
  v_or_b32 v163, v163, v171
  v_cndmask_b32 v164, 0, v169, s[80:81]
  v_cndmask_b32 v171, 0, v170, s[82:83]
  v_or_b32 v164, v164, v171
  v_cndmask_b32 v165, 0, v169, s[84:85]
  v_cndmask_b32 v171, 0, v170, s[86:87]
  v_or_b32 v165, v165, v171
  v_cndmask_b32 v166, 0, v169, s[88:89]
  v_cndmask_b32 v171, 0, v170, s[90:91]
  v_or_b32 v166, v166, v171
  v_cndmask_b32 v167, 0, v169, s[92:93]
  v_cndmask_b32 v171, 0, v170, s[94:95]
  v_or_b32 v167, v167, v171
  v_mov_b32 v144, 0x3f803f80
  v_mov_b32 v145, 0x3f803f80
  v_mov_b32 v146, 0x3f803f80
  v_mov_b32 v147, 0x3f803f80
  v_mov_b32 v148, 0x3f803f80
  v_mov_b32 v149, 0x3f803f80
  v_mov_b32 v150, 0x3f803f80
  v_mov_b32 v151, 0x3f803f80
  v_mov_b32 v152, 0x3f803f80
  v_mov_b32 v153, 0x3f803f80
  v_mov_b32 v154, 0x3f803f80
  v_mov_b32 v155, 0x3f803f80
  v_mov_b32 v156, 0x3f803f80
  v_mov_b32 v157, 0x3f803f80
  v_mov_b32 v158, 0x3f803f80
  v_mov_b32 v159, 0x3f803f80
  s_lshr_b32 s62, s50, 3
  s_lshl_b32 s63, s49, 1
  v_and_b32 v40, 3, v186
  v_add_u32 v40, s63, v40
  v_subrev_u32 v40, 2, v40
  v_max_i32 v40, 0, v40
  v_and_b32 v41, 1, v186
  v_add_u32 v41, s63, v41
  v_lshrrev_b32 v42, 2, v186
  v_add_u32 v42, 1, v42
  v_cmp_gt_u32 vcc, 8, v186
  s_nop 1
  v_cndmask_b32 v40, v41, v40, vcc
  v_cndmask_b32 v42, 0, v42, vcc
  v_lshlrev_b32 v42, 2, v42
  v_add_u32 v42, s62, v42
  v_lshl_add_u32 v40, v42, 4, v40
  v_lshlrev_b32 v40, 7, v40
  v_add_u32 v40, 32768, v40
  v_lshlrev_b32 v43, 4, v186
  s_lshl_b32 s62, s49, 3
  s_lshl_b32 s63, s48, 1
  s_add_u32 s63, s63, s62
  s_sub_u32 s63, s63, 8
  s_lshl_b32 s63, s63, 5
  s_add_u32 s63, s63, s50
  s_lshl_b32 s63, s63, 10
  v_add_u32 v44, s63, v43
  s_cmp_lt_i32 s63, 0
  s_cbranch_scc0 L_kvok
  v_mov_b32 v44, 0x7ff00000
L_kvok:
  s_add_u32 s62, s62, s48
  s_lshl_b32 s62, s62, 5
  s_add_u32 s62, s62, s50
  s_lshl_b32 s62, s62, 10
  s_waitcnt lgkmcnt(0)
  s_cmp_lg_u32 s48, 0
  s_cbranch_scc1 wp_14
  s_mov_b32 s55, 0x40000
poll_15:
  buffer_load_dword v41, v40, s[28:31], 0 offen sc1
  s_waitcnt vmcnt(0)
  v_cmp_ne_u32 vcc, s51, v41
  s_cbranch_vccz pdone_16
  s_sleep 2
  s_sub_u32 s55, s55, 1
  s_cmp_lg_u32 s55, 0
  s_cbranch_scc1 poll_15
  s_mov_b32 s99, 1
pdone_16:
wp_14:
  s_barrier
  s_add_u32 s63, s62, 1048576
  buffer_load_dwordx4 v[36:39], v43, s[28:31], s63 offen sc1
  s_mov_b32 s63, 3145728
  s_add_u32 m0, s52, 131072
  s_nop 0
  buffer_load_dwordx4 v44, s[28:31], s63 offen sc1 lds
  s_mov_b32 s63, 3178496
  s_add_u32 m0, s52, 132096
  s_nop 0
  buffer_load_dwordx4 v44, s[28:31], s63 offen sc1 lds
  s_mov_b32 s63, 5242880
  s_add_u32 m0, s52, 147456
  s_nop 0
  buffer_load_dwordx4 v44, s[28:31], s63 offen sc1 lds
  s_mov_b32 s63, 5275648
  s_add_u32 m0, s52, 148480
  s_nop 0
  buffer_load_dwordx4 v44, s[28:31], s63 offen sc1 lds
  s_lshl_b32 s63, s48, 10
  v_add_u32 v168, s63, v43
  v_add_u32 v168, 131072, v168
  v_and_b32 v169, 15, v186
  v_lshrrev_b32 v170, 5, v186
  v_lshl_add_u32 v169, v170, 4, v169
  v_lshlrev_b32 v169, 4, v169
  v_add_u32 v169, s63, v169
  v_add_u32 v169, 147456, v169
  s_sub_u32 s60, 8, s48
  s_cmp_eq_u32 s49, 0
  s_cselect_b32 s60, s60, 0
  s_mov_b32 s2, 0x0000ffff
  s_mov_b32 s3, 0x0000ffff
  s_waitcnt vmcnt(0)
L_w1n:
  s_barrier
  s_cmp_ge_u32 s48, 4
  s_cbranch_scc1 L_p2_pr
  s_setprio 1
L_p2_pr:
  ds_read_b128 v[32:35], v168 offset:8192
  ds_read_b128 v[0:3], v168 offset:0
  ds_read_b128 v[28:31], v168 offset:7168
  ds_read_b128 v[24:27], v168 offset:6144
  ds_read_b128 v[20:23], v168 offset:5120
  ds_read_b128 v[16:19], v168 offset:4096
  ds_read_b128 v[12:15], v168 offset:3072
  ds_read_b128 v[8:11], v168 offset:2048
  ds_read_b128 v[4:7], v168 offset:1024
  s_mov_b64 exec, s[2:3]
  ds_read_b128 v[144:147], v169 offset:8192
  ds_read_b128 v[148:151], v169 offset:8704
  s_mov_b64 exec, -1
  s_mov_b64 exec, s[2:3]
  ds_read_b128 v[152:155], v169 offset:0
  ds_read_b128 v[156:159], v169 offset:512
  s_mov_b64 exec, -1
  s_waitcnt lgkmcnt(11)
  v_mfma_f32_32x32x16_bf16 v[40:55], v[32:35], v[36:39], 0
  v_mfma_f32_32x32x16_bf16 v[56:71], v[0:3], v[36:39], 0
  s_waitcnt lgkmcnt(4)
  s_cmp_eq_u32 s60, 0
  s_cbranch_scc1 L_p2_f0
  s_nop 7
  s_nop 3
  v_mov_b32 v56, 0xff7fffff
  v_mov_b32 v57, 0xff7fffff
  v_mov_b32 v58, 0xff7fffff
  v_mov_b32 v59, 0xff7fffff
  v_mov_b32 v60, 0xff7fffff
  v_mov_b32 v61, 0xff7fffff
  v_mov_b32 v62, 0xff7fffff
  v_mov_b32 v63, 0xff7fffff
  v_mov_b32 v64, 0xff7fffff
  v_mov_b32 v65, 0xff7fffff
  v_mov_b32 v66, 0xff7fffff
  v_mov_b32 v67, 0xff7fffff
  v_mov_b32 v68, 0xff7fffff
  v_mov_b32 v69, 0xff7fffff
  v_mov_b32 v70, 0xff7fffff
  v_mov_b32 v71, 0xff7fffff
L_p2_f0:
  s_nop 7
  s_nop 1
  v_cndmask_b32 v72, v56, v40, s[64:65]
  v_cndmask_b32 v73, v57, v41, s[66:67]
  v_cndmask_b32 v74, v58, v42, s[68:69]
  v_cndmask_b32 v75, v59, v43, s[70:71]
  v_cndmask_b32 v76, v60, v44, s[72:73]
  v_cndmask_b32 v77, v61, v45, s[74:75]
  v_cndmask_b32 v78, v62, v46, s[76:77]
  v_cndmask_b32 v79, v63, v47, s[78:79]
  v_cndmask_b32 v80, v64, v48, s[80:81]
  v_cndmask_b32 v81, v65, v49, s[82:83]
  v_cndmask_b32 v82, v66, v50, s[84:85]
  v_cndmask_b32 v83, v67, v51, s[86:87]
  v_cndmask_b32 v84, v68, v52, s[88:89]
  v_cndmask_b32 v85, v69, v53, s[90:91]
  v_cndmask_b32 v86, v70, v54, s[92:93]
  v_cndmask_b32 v87, v71, v55, s[94:95]
  v_mfma_f32_32x32x16_bf16 v[40:55], v[28:31], v[36:39], 0
  v_max3_f32 v170, v72, v73, v74
  v_max3_f32 v171, v75, v76, v77
  v_max3_f32 v170, v170, v78, v79
  v_max3_f32 v171, v171, v80, v81
  v_max3_f32 v170, v170, v82, v83
  v_max3_f32 v171, v171, v84, v85
  v_max3_f32 v170, v170, v86, v87
  s_nop 1
  s_cmp_gt_u32 s60, 7
  s_cbranch_scc1 L_p2_max
  v_mfma_f32_32x32x16_bf16 v[56:71], v[24:27], v[36:39], 0
  v_max3_f32 v170, v170, v40, v41
  v_max3_f32 v171, v171, v42, v43
  v_max3_f32 v170, v170, v44, v45
  v_max3_f32 v171, v171, v46, v47
  v_max3_f32 v170, v170, v48, v49
  v_max3_f32 v171, v171, v50, v51
  v_max3_f32 v170, v170, v52, v53
  v_max3_f32 v171, v171, v54, v55
  s_nop 0
  s_cmp_gt_u32 s60, 6
  s_cbranch_scc1 L_p2_max
  v_mfma_f32_32x32x16_bf16 v[40:55], v[20:23], v[36:39], 0
  v_max3_f32 v170, v170, v56, v57
  v_max3_f32 v171, v171, v58, v59
  v_max3_f32 v170, v170, v60, v61
  v_max3_f32 v171, v171, v62, v63
  v_max3_f32 v170, v170, v64, v65
  v_max3_f32 v171, v171, v66, v67
  v_max3_f32 v170, v170, v68, v69
  v_max3_f32 v171, v171, v70, v71
  s_nop 0
  s_cmp_gt_u32 s60, 5
  s_cbranch_scc1 L_p2_max
  v_mfma_f32_32x32x16_bf16 v[56:71], v[16:19], v[36:39], 0
  v_max3_f32 v170, v170, v40, v41
  v_max3_f32 v171, v171, v42, v43
  v_max3_f32 v170, v170, v44, v45
  v_max3_f32 v171, v171, v46, v47
  v_max3_f32 v170, v170, v48, v49
  v_max3_f32 v171, v171, v50, v51
  v_max3_f32 v170, v170, v52, v53
  v_max3_f32 v171, v171, v54, v55
  s_nop 0
  s_cmp_gt_u32 s60, 4
  s_cbranch_scc1 L_p2_max
  v_mfma_f32_32x32x16_bf16 v[40:55], v[12:15], v[36:39], 0
  v_max3_f32 v170, v170, v56, v57
  v_max3_f32 v171, v171, v58, v59
  v_max3_f32 v170, v170, v60, v61
  v_max3_f32 v171, v171, v62, v63
  v_max3_f32 v170, v170, v64, v65
  v_max3_f32 v171, v171, v66, v67
  v_max3_f32 v170, v170, v68, v69
  v_max3_f32 v171, v171, v70, v71
  s_nop 0
  s_cmp_gt_u32 s60, 3
  s_cbranch_scc1 L_p2_max
  v_mfma_f32_32x32x16_bf16 v[56:71], v[8:11], v[36:39], 0
  v_max3_f32 v170, v170, v40, v41
  v_max3_f32 v171, v171, v42, v43
  v_max3_f32 v170, v170, v44, v45
  v_max3_f32 v171, v171, v46, v47
  v_max3_f32 v170, v170, v48, v49
  v_max3_f32 v171, v171, v50, v51
  v_max3_f32 v170, v170, v52, v53
  v_max3_f32 v171, v171, v54, v55
  s_nop 0
  s_cmp_gt_u32 s60, 2
  s_cbranch_scc1 L_p2_max
  v_mfma_f32_32x32x16_bf16 v[40:55], v[4:7], v[36:39], 0
  v_max3_f32 v170, v170, v56, v57
  v_max3_f32 v171, v171, v58, v59
  v_max3_f32 v170, v170, v60, v61
  v_max3_f32 v171, v171, v62, v63
  v_max3_f32 v170, v170, v64, v65
  v_max3_f32 v171, v171, v66, v67
  v_max3_f32 v170, v170, v68, v69
  v_max3_f32 v171, v171, v70, v71
  s_nop 0
  s_cmp_gt_u32 s60, 1
  s_cbranch_scc1 L_p2_max
  s_nop 0
  v_max3_f32 v170, v170, v40, v41
  v_max3_f32 v171, v171, v42, v43
  v_max3_f32 v170, v170, v44, v45
  v_max3_f32 v171, v171, v46, v47
  v_max3_f32 v170, v170, v48, v49
  v_max3_f32 v171, v171, v50, v51
  v_max3_f32 v170, v170, v52, v53
  v_max3_f32 v171, v171, v54, v55
  s_nop 0
L_p2_max:
  v_max_f32 v170, v170, v171
  v_mov_b32 v171, v170
  s_nop 1
  v_permlane32_swap_b32 v171, v170
  s_nop 1
  v_max_f32 v170, v170, v171
  v_sub_f32 v88, 0, v170
  v_sub_f32 v89, 0, v170
  v_sub_f32 v90, 0, v170
  v_sub_f32 v91, 0, v170
  v_sub_f32 v92, 0, v170
  v_sub_f32 v93, 0, v170
  v_sub_f32 v94, 0, v170
  v_sub_f32 v95, 0, v170
  v_sub_f32 v96, 0, v170
  v_sub_f32 v97, 0, v170
  v_sub_f32 v98, 0, v170
  v_sub_f32 v99, 0, v170
  v_sub_f32 v100, 0, v170
  v_sub_f32 v101, 0, v170
  v_sub_f32 v102, 0, v170
  v_sub_f32 v103, 0, v170
  s_nop 1
  v_mfma_f32_32x32x16_bf16 v[40:55], v[28:31], v[36:39], v[88:103]
  s_min_u32 s63, s48, 6
  s_mul_i32 s61, s50, 7
  s_add_u32 s63, s63, s61
  s_lshl_b32 s63, s63, 13
  v_lshlrev_b32 v176, 7, v186
  buffer_load_dword v177, v176, s[24:27], s63 offen
  v_sub_f32 v72, v72, v170
  v_sub_f32 v73, v73, v170
  v_sub_f32 v74, v74, v170
  v_sub_f32 v75, v75, v170
  v_sub_f32 v76, v76, v170
  v_sub_f32 v77, v77, v170
  v_sub_f32 v78, v78, v170
  v_sub_f32 v79, v79, v170
  v_sub_f32 v80, v80, v170
  v_sub_f32 v81, v81, v170
  v_sub_f32 v82, v82, v170
  v_sub_f32 v83, v83, v170
  v_sub_f32 v84, v84, v170
  v_sub_f32 v85, v85, v170
  v_sub_f32 v86, v86, v170
  v_sub_f32 v87, v87, v170
  v_exp_f32 v72, v72
  v_exp_f32 v73, v73
  v_exp_f32 v74, v74
  v_exp_f32 v75, v75
  v_exp_f32 v76, v76
  v_exp_f32 v77, v77
  v_exp_f32 v78, v78
  v_exp_f32 v79, v79
  v_exp_f32 v80, v80
  v_exp_f32 v81, v81
  v_exp_f32 v82, v82
  v_exp_f32 v83, v83
  v_exp_f32 v84, v84
  v_exp_f32 v85, v85
  v_exp_f32 v86, v86
  v_exp_f32 v87, v87
  v_cvt_pk_bf16_f32 v120, v72, v73
  v_cvt_pk_bf16_f32 v121, v74, v75
  v_cvt_pk_bf16_f32 v122, v76, v77
  v_cvt_pk_bf16_f32 v123, v78, v79
  v_cvt_pk_bf16_f32 v124, v80, v81
  v_cvt_pk_bf16_f32 v125, v82, v83
  v_cvt_pk_bf16_f32 v126, v84, v85
  v_cvt_pk_bf16_f32 v127, v86, v87
  v_and_b32 v128, v120, v160
  v_and_b32 v129, v121, v161
  v_and_b32 v130, v122, v162
  v_and_b32 v131, v123, v163
  v_and_b32 v132, v124, v164
  v_and_b32 v133, v125, v165
  v_and_b32 v134, v126, v166
  v_and_b32 v135, v127, v167
  v_xor_b32 v136, v120, v128
  v_xor_b32 v137, v121, v129
  v_xor_b32 v138, v122, v130
  v_xor_b32 v139, v123, v131
  v_xor_b32 v140, v124, v132
  v_xor_b32 v141, v125, v133
  v_xor_b32 v142, v126, v134
  v_xor_b32 v143, v127, v135
  s_waitcnt lgkmcnt(0)
  v_mfma_f32_32x32x16_bf16 v[104:119], v[144:147], v[128:131], 0
  v_mfma_f32_32x32x16_bf16 v[104:119], v[148:151], v[132:135], v[104:119]
  s_cmp_lg_u32 s60, 0
  s_cbranch_scc1 L_p2_nof
  v_mfma_f32_32x32x16_bf16 v[104:119], v[152:155], v[136:139], v[104:119]
  v_mfma_f32_32x32x16_bf16 v[104:119], v[156:159], v[140:143], v[104:119]
L_p2_nof:
  s_mov_b64 exec, s[2:3]
  ds_read_b128 v[144:147], v169 offset:7168
  ds_read_b128 v[148:151], v169 offset:7680
  s_mov_b64 exec, -1
  s_cmp_gt_u32 s60, 7
  s_cbranch_scc1 L_p2_fin
  v_mfma_f32_32x32x16_bf16 v[56:71], v[24:27], v[36:39], v[88:103]
  v_exp_f32 v40, v40
  v_exp_f32 v41, v41
  v_exp_f32 v42, v42
  v_exp_f32 v43, v43
  v_exp_f32 v44, v44
  v_exp_f32 v45, v45
  v_exp_f32 v46, v46
  v_exp_f32 v47, v47
  s_mov_b64 exec, s[2:3]
  ds_read_b128 v[152:155], v169 offset:6144
  ds_read_b128 v[156:159], v169 offset:6656
  s_mov_b64 exec, -1
  v_exp_f32 v48, v48
  v_exp_f32 v49, v49
  v_exp_f32 v50, v50
  v_exp_f32 v51, v51
  v_exp_f32 v52, v52
  v_exp_f32 v53, v53
  v_exp_f32 v54, v54
  v_exp_f32 v55, v55
  v_cvt_pk_bf16_f32 v120, v40, v41
  v_cvt_pk_bf16_f32 v121, v42, v43
  v_cvt_pk_bf16_f32 v122, v44, v45
  v_cvt_pk_bf16_f32 v123, v46, v47
  v_cvt_pk_bf16_f32 v124, v48, v49
  v_cvt_pk_bf16_f32 v125, v50, v51
  v_cvt_pk_bf16_f32 v126, v52, v53
  v_cvt_pk_bf16_f32 v127, v54, v55
  s_waitcnt lgkmcnt(2)
  s_nop 0
  v_mfma_f32_32x32x16_bf16 v[104:119], v[144:147], v[120:123], v[104:119]
  v_mfma_f32_32x32x16_bf16 v[104:119], v[148:151], v[124:127], v[104:119]
  s_cmp_gt_u32 s60, 6
  s_cbranch_scc1 L_p2_fin
  v_mfma_f32_32x32x16_bf16 v[40:55], v[20:23], v[36:39], v[88:103]
  v_exp_f32 v56, v56
  v_exp_f32 v57, v57
  v_exp_f32 v58, v58
  v_exp_f32 v59, v59
  v_exp_f32 v60, v60
  v_exp_f32 v61, v61
  v_exp_f32 v62, v62
  v_exp_f32 v63, v63
  s_mov_b64 exec, s[2:3]
  ds_read_b128 v[144:147], v169 offset:5120
  ds_read_b128 v[148:151], v169 offset:5632
  s_mov_b64 exec, -1
  v_exp_f32 v64, v64
  v_exp_f32 v65, v65
  v_exp_f32 v66, v66
  v_exp_f32 v67, v67
  v_exp_f32 v68, v68
  v_exp_f32 v69, v69
  v_exp_f32 v70, v70
  v_exp_f32 v71, v71
  v_cvt_pk_bf16_f32 v120, v56, v57
  v_cvt_pk_bf16_f32 v121, v58, v59
  v_cvt_pk_bf16_f32 v122, v60, v61
  v_cvt_pk_bf16_f32 v123, v62, v63
  v_cvt_pk_bf16_f32 v124, v64, v65
  v_cvt_pk_bf16_f32 v125, v66, v67
  v_cvt_pk_bf16_f32 v126, v68, v69
  v_cvt_pk_bf16_f32 v127, v70, v71
  s_waitcnt lgkmcnt(2)
  s_nop 0
  v_mfma_f32_32x32x16_bf16 v[104:119], v[152:155], v[120:123], v[104:119]
  v_mfma_f32_32x32x16_bf16 v[104:119], v[156:159], v[124:127], v[104:119]
  s_cmp_gt_u32 s60, 5
  s_cbranch_scc1 L_p2_fin
  v_mfma_f32_32x32x16_bf16 v[56:71], v[16:19], v[36:39], v[88:103]
  v_exp_f32 v40, v40
  v_exp_f32 v41, v41
  v_exp_f32 v42, v42
  v_exp_f32 v43, v43
  v_exp_f32 v44, v44
  v_exp_f32 v45, v45
  v_exp_f32 v46, v46
  v_exp_f32 v47, v47
  s_mov_b64 exec, s[2:3]
  ds_read_b128 v[152:155], v169 offset:4096
  ds_read_b128 v[156:159], v169 offset:4608
  s_mov_b64 exec, -1
  v_exp_f32 v48, v48
  v_exp_f32 v49, v49
  v_exp_f32 v50, v50
  v_exp_f32 v51, v51
  v_exp_f32 v52, v52
  v_exp_f32 v53, v53
  v_exp_f32 v54, v54
  v_exp_f32 v55, v55
  v_cvt_pk_bf16_f32 v120, v40, v41
  v_cvt_pk_bf16_f32 v121, v42, v43
  v_cvt_pk_bf16_f32 v122, v44, v45
  v_cvt_pk_bf16_f32 v123, v46, v47
  v_cvt_pk_bf16_f32 v124, v48, v49
  v_cvt_pk_bf16_f32 v125, v50, v51
  v_cvt_pk_bf16_f32 v126, v52, v53
  v_cvt_pk_bf16_f32 v127, v54, v55
  s_waitcnt lgkmcnt(2)
  s_nop 0
  v_mfma_f32_32x32x16_bf16 v[104:119], v[144:147], v[120:123], v[104:119]
  v_mfma_f32_32x32x16_bf16 v[104:119], v[148:151], v[124:127], v[104:119]
  s_cmp_gt_u32 s60, 4
  s_cbranch_scc1 L_p2_fin
  v_mfma_f32_32x32x16_bf16 v[40:55], v[12:15], v[36:39], v[88:103]
  v_exp_f32 v56, v56
  v_exp_f32 v57, v57
  v_exp_f32 v58, v58
  v_exp_f32 v59, v59
  v_exp_f32 v60, v60
  v_exp_f32 v61, v61
  v_exp_f32 v62, v62
  v_exp_f32 v63, v63
  s_mov_b64 exec, s[2:3]
  ds_read_b128 v[144:147], v169 offset:3072
  ds_read_b128 v[148:151], v169 offset:3584
  s_mov_b64 exec, -1
  v_exp_f32 v64, v64
  v_exp_f32 v65, v65
  v_exp_f32 v66, v66
  v_exp_f32 v67, v67
  v_exp_f32 v68, v68
  v_exp_f32 v69, v69
  v_exp_f32 v70, v70
  v_exp_f32 v71, v71
  v_cvt_pk_bf16_f32 v120, v56, v57
  v_cvt_pk_bf16_f32 v121, v58, v59
  v_cvt_pk_bf16_f32 v122, v60, v61
  v_cvt_pk_bf16_f32 v123, v62, v63
  v_cvt_pk_bf16_f32 v124, v64, v65
  v_cvt_pk_bf16_f32 v125, v66, v67
  v_cvt_pk_bf16_f32 v126, v68, v69
  v_cvt_pk_bf16_f32 v127, v70, v71
  s_waitcnt lgkmcnt(2)
  s_nop 0
  v_mfma_f32_32x32x16_bf16 v[104:119], v[152:155], v[120:123], v[104:119]
  v_mfma_f32_32x32x16_bf16 v[104:119], v[156:159], v[124:127], v[104:119]
  s_cmp_gt_u32 s60, 3
  s_cbranch_scc1 L_p2_fin
  v_mfma_f32_32x32x16_bf16 v[56:71], v[8:11], v[36:39], v[88:103]
  v_exp_f32 v40, v40
  v_exp_f32 v41, v41
  v_exp_f32 v42, v42
  v_exp_f32 v43, v43
  v_exp_f32 v44, v44
  v_exp_f32 v45, v45
  v_exp_f32 v46, v46
  v_exp_f32 v47, v47
  s_mov_b64 exec, s[2:3]
  ds_read_b128 v[152:155], v169 offset:2048
  ds_read_b128 v[156:159], v169 offset:2560
  s_mov_b64 exec, -1
  v_exp_f32 v48, v48
  v_exp_f32 v49, v49
  v_exp_f32 v50, v50
  v_exp_f32 v51, v51
  v_exp_f32 v52, v52
  v_exp_f32 v53, v53
  v_exp_f32 v54, v54
  v_exp_f32 v55, v55
  v_cvt_pk_bf16_f32 v120, v40, v41
  v_cvt_pk_bf16_f32 v121, v42, v43
  v_cvt_pk_bf16_f32 v122, v44, v45
  v_cvt_pk_bf16_f32 v123, v46, v47
  v_cvt_pk_bf16_f32 v124, v48, v49
  v_cvt_pk_bf16_f32 v125, v50, v51
  v_cvt_pk_bf16_f32 v126, v52, v53
  v_cvt_pk_bf16_f32 v127, v54, v55
  s_waitcnt lgkmcnt(2)
  s_nop 0
  v_mfma_f32_32x32x16_bf16 v[104:119], v[144:147], v[120:123], v[104:119]
  v_mfma_f32_32x32x16_bf16 v[104:119], v[148:151], v[124:127], v[104:119]
  s_cmp_gt_u32 s60, 2
  s_cbranch_scc1 L_p2_fin
  v_mfma_f32_32x32x16_bf16 v[40:55], v[4:7], v[36:39], v[88:103]
  v_exp_f32 v56, v56
  v_exp_f32 v57, v57
  v_exp_f32 v58, v58
  v_exp_f32 v59, v59
  v_exp_f32 v60, v60
  v_exp_f32 v61, v61
  v_exp_f32 v62, v62
  v_exp_f32 v63, v63
  s_mov_b64 exec, s[2:3]
  ds_read_b128 v[144:147], v169 offset:1024
  ds_read_b128 v[148:151], v169 offset:1536
  s_mov_b64 exec, -1
  v_exp_f32 v64, v64
  v_exp_f32 v65, v65
  v_exp_f32 v66, v66
  v_exp_f32 v67, v67
  v_exp_f32 v68, v68
  v_exp_f32 v69, v69
  v_exp_f32 v70, v70
  v_exp_f32 v71, v71
  v_cvt_pk_bf16_f32 v120, v56, v57
  v_cvt_pk_bf16_f32 v121, v58, v59
  v_cvt_pk_bf16_f32 v122, v60, v61
  v_cvt_pk_bf16_f32 v123, v62, v63
  v_cvt_pk_bf16_f32 v124, v64, v65
  v_cvt_pk_bf16_f32 v125, v66, v67
  v_cvt_pk_bf16_f32 v126, v68, v69
  v_cvt_pk_bf16_f32 v127, v70, v71
  s_waitcnt lgkmcnt(2)
  s_nop 0
  v_mfma_f32_32x32x16_bf16 v[104:119], v[152:155], v[120:123], v[104:119]
  v_mfma_f32_32x32x16_bf16 v[104:119], v[156:159], v[124:127], v[104:119]
  s_cmp_gt_u32 s60, 1
  s_cbranch_scc1 L_p2_fin
  v_exp_f32 v40, v40
  v_exp_f32 v41, v41
  v_exp_f32 v42, v42
  v_exp_f32 v43, v43
  v_exp_f32 v44, v44
  v_exp_f32 v45, v45
  v_exp_f32 v46, v46
  v_exp_f32 v47, v47
  v_exp_f32 v48, v48
  v_exp_f32 v49, v49
  v_exp_f32 v50, v50
  v_exp_f32 v51, v51
  v_exp_f32 v52, v52
  v_exp_f32 v53, v53
  v_exp_f32 v54, v54
  v_exp_f32 v55, v55
  v_cvt_pk_bf16_f32 v120, v40, v41
  v_cvt_pk_bf16_f32 v121, v42, v43
  v_cvt_pk_bf16_f32 v122, v44, v45
  v_cvt_pk_bf16_f32 v123, v46, v47
  v_cvt_pk_bf16_f32 v124, v48, v49
  v_cvt_pk_bf16_f32 v125, v50, v51
  v_cvt_pk_bf16_f32 v126, v52, v53
  v_cvt_pk_bf16_f32 v127, v54, v55
  s_waitcnt lgkmcnt(0)
  s_nop 0
  v_mfma_f32_32x32x16_bf16 v[104:119], v[144:147], v[120:123], v[104:119]
  v_mfma_f32_32x32x16_bf16 v[104:119], v[148:151], v[124:127], v[104:119]
L_p2_fin:
  s_nop 7
  s_nop 3
  v_rcp_f32 v170, v112
  s_add_u32 s63, s62, 7340032
  v_mul_f32 v104, v170, v104
  v_mul_f32 v105, v170, v105
  v_mul_f32 v106, v170, v106
  v_mul_f32 v107, v170, v107
  v_mul_f32 v108, v170, v108
  v_mul_f32 v109, v170, v109
  v_mul_f32 v110, v170, v110
  v_mul_f32 v111, v170, v111
  v_cvt_pk_bf16_f32 v120, v104, v105
  v_cvt_pk_bf16_f32 v121, v106, v107
  v_cvt_pk_bf16_f32 v122, v108, v109
  v_cvt_pk_bf16_f32 v123, v110, v111
  v_lshlrev_b32 v171, 4, v186
  buffer_store_dwordx4 v[120:123], v171, s[28:31], s63 offen sc1
  s_lshl_b32 s62, s49, 5
  s_add_u32 s62, s62, s50
  s_lshl_b32 s62, s62, 7
  s_add_u32 s62, s62, 65536
  s_setprio 0
  s_waitcnt vmcnt(0)
  s_barrier
  s_cmp_lg_u32 s48, 0
  s_cbranch_scc1 sf_17
  s_cmp_eq_u32 s62, 0
  s_cbranch_scc1 sf_17
  v_mov_b32 v40, s51
  v_mov_b32 v41, 0
  s_mov_b64 exec, 1
  buffer_store_dword v40, v41, s[28:31], s62 offen sc1
  s_mov_b64 exec, -1
sf_17:
  s_lshl_b32 s60, s56, 1
  s_add_u32 s60, s60, s53
  s_lshl_b32 s62, s60, 5
  s_lshl_b32 s63, s54, 3
  s_add_u32 s62, s62, s63
  s_lshl_b32 s63, s49, 12
  s_add_u32 s63, s63, 65536
  v_and_b32 v64, 31, v186
  v_lshl_add_u32 v64, v64, 7, s63
  s_lshl_b32 s62, s62, 10
  s_add_u32 s62, s62, 7340032
  s_add_u32 s63, s62, 4096
  v_lshlrev_b32 v66, 4, v186
  s_cmp_lg_u32 s48, 0
  s_cbranch_scc1 wp_18
  s_mov_b32 s55, 0x40000
poll_19:
  buffer_load_dword v65, v64, s[28:31], 0 offen sc1
  s_waitcnt vmcnt(0)
  v_cmp_ne_u32 vcc, s51, v65
  s_cbranch_vccz pdone_20
  s_sleep 2
  s_sub_u32 s55, s55, 1
  s_cmp_lg_u32 s55, 0
  s_cbranch_scc1 poll_19
  s_mov_b32 s99, 1
pdone_20:
wp_18:
  s_barrier
  buffer_load_dwordx4 v[0:3], v66, s[28:31], s62 offen offset:0 sc1
  buffer_load_dwordx4 v[4:7], v66, s[28:31], s62 offen offset:1024 sc1
  buffer_load_dwordx4 v[8:11], v66, s[28:31], s62 offen offset:2048 sc1
  buffer_load_dwordx4 v[12:15], v66, s[28:31], s62 offen offset:3072 sc1
  buffer_load_dwordx4 v[16:19], v66, s[28:31], s63 offen offset:0 sc1
  buffer_load_dwordx4 v[20:23], v66, s[28:31], s63 offen offset:1024 sc1
  buffer_load_dwordx4 v[24:27], v66, s[28:31], s63 offen offset:2048 sc1
  buffer_load_dwordx4 v[28:31], v66, s[28:31], s63 offen offset:3072 sc1
  s_waitcnt vmcnt(7)
  v_mfma_f32_32x32x16_bf16 v[128:143], v[192:195], v[0:3], 0
  v_mfma_f32_32x32x16_bf16 v[144:159], v[196:199], v[0:3], 0
  s_waitcnt vmcnt(6)
  v_mfma_f32_32x32x16_bf16 v[128:143], v[200:203], v[4:7], v[128:143]
  v_mfma_f32_32x32x16_bf16 v[144:159], v[204:207], v[4:7], v[144:159]
  s_waitcnt vmcnt(5)
  v_mfma_f32_32x32x16_bf16 v[128:143], v[208:211], v[8:11], v[128:143]
  v_mfma_f32_32x32x16_bf16 v[144:159], v[212:215], v[8:11], v[144:159]
  s_waitcnt vmcnt(4)
  v_mfma_f32_32x32x16_bf16 v[128:143], v[216:219], v[12:15], v[128:143]
  v_mfma_f32_32x32x16_bf16 v[144:159], v[220:223], v[12:15], v[144:159]
  s_waitcnt vmcnt(3)
  v_mfma_f32_32x32x16_bf16 v[128:143], v[224:227], v[16:19], v[128:143]
  v_mfma_f32_32x32x16_bf16 v[144:159], v[228:231], v[16:19], v[144:159]
  s_waitcnt vmcnt(2)
  v_mfma_f32_32x32x16_bf16 v[128:143], v[232:235], v[20:23], v[128:143]
  v_mfma_f32_32x32x16_bf16 v[144:159], v[236:239], v[20:23], v[144:159]
  s_waitcnt vmcnt(1)
  v_mfma_f32_32x32x16_bf16 v[128:143], v[240:243], v[24:27], v[128:143]
  v_mfma_f32_32x32x16_bf16 v[144:159], v[244:247], v[24:27], v[144:159]
  s_waitcnt vmcnt(0)
  v_mfma_f32_32x32x16_bf16 v[128:143], v[248:251], v[28:31], v[128:143]
  v_mfma_f32_32x32x16_bf16 v[144:159], v[252:255], v[28:31], v[144:159]
  v_lshlrev_b32 v160, 4, v186
  s_xor_b32 s62, s48, 2
  s_lshl_b32 s62, s62, 12
  s_add_u32 s62, s62, 131072
  v_add_u32 v161, s62, v160
  s_lshl_b32 s62, s48, 12
  s_add_u32 s62, s62, 131072
  v_add_u32 v162, s62, v160
  s_add_u32 s63, s54, 3
  s_and_b32 s63, s63, 3
  s_lshl_b32 s2, s53, 2
  s_add_u32 s63, s63, s2
  s_lshl_b32 s63, s63, 12
  s_add_u32 s63, s63, 131072
  v_add_u32 v163, s63, v160
  ds_write_b128 v161, v[144:147] offset:0
  ds_write_b128 v161, v[148:151] offset:1024
  ds_write_b128 v161, v[152:155] offset:2048
  ds_write_b128 v161, v[156:159] offset:3072
  s_waitcnt lgkmcnt(0)
  s_barrier
  ds_read_b128 v[200:203], v162 offset:2048
  ds_read_b128 v[204:207], v162 offset:3072
  ds_read_b128 v[192:195], v162 offset:0
  ds_read_b128 v[196:199], v162 offset:1024
  s_waitcnt lgkmcnt(2)
  v_pk_add_f32 v[136:137], v[136:137], v[200:201]
  v_pk_add_f32 v[138:139], v[138:139], v[202:203]
  v_pk_add_f32 v[140:141], v[140:141], v[204:205]
  v_pk_add_f32 v[142:143], v[142:143], v[206:207]
  s_waitcnt lgkmcnt(0)
  ds_write_b128 v162, v[136:139] offset:0
  ds_write_b128 v162, v[140:143] offset:1024
  v_pk_add_f32 v[128:129], v[128:129], v[192:193]
  v_pk_add_f32 v[130:131], v[130:131], v[194:195]
  v_pk_add_f32 v[132:133], v[132:133], v[196:197]
  v_pk_add_f32 v[134:135], v[134:135], v[198:199]
  s_waitcnt lgkmcnt(0)
  s_barrier
  ds_read_b128 v[192:195], v163 offset:0
  ds_read_b128 v[196:199], v163 offset:1024
  s_lshl_b32 s62, s60, 5
  s_lshl_b32 s63, s57, 2
  s_add_u32 s62, s62, s63
  s_add_u32 s62, s62, s54
  s_lshl_b32 s63, s62, 10
  s_add_u32 s63, s63, 9437184
  s_waitcnt lgkmcnt(0)
  v_pk_add_f32 v[128:129], v[128:129], v[192:193]
  v_pk_add_f32 v[130:131], v[130:131], v[194:195]
  v_pk_add_f32 v[132:133], v[132:133], v[196:197]
  v_pk_add_f32 v[134:135], v[134:135], v[198:199]
  v_lshlrev_b32 v192, 16, v188
  v_and_b32 v193, 0xffff0000, v188
  v_lshlrev_b32 v194, 16, v189
  v_and_b32 v195, 0xffff0000, v189
  v_lshlrev_b32 v196, 16, v190
  v_and_b32 v197, 0xffff0000, v190
  v_lshlrev_b32 v198, 16, v191
  v_and_b32 v199, 0xffff0000, v191
  v_pk_add_f32 v[128:129], v[128:129], v[192:193]
  v_pk_add_f32 v[130:131], v[130:131], v[194:195]
  v_pk_add_f32 v[132:133], v[132:133], v[196:197]
  v_pk_add_f32 v[134:135], v[134:135], v[198:199]
  v_cvt_pk_bf16_f32 v188, v128, v129
  v_cvt_pk_bf16_f32 v189, v130, v131
  v_cvt_pk_bf16_f32 v190, v132, v133
  v_cvt_pk_bf16_f32 v191, v134, v135
  buffer_store_dwordx4 v[188:191], v160, s[28:31], s63 offen sc1
  s_mov_b32 s61, s63
  s_mov_b32 s2, 0x3f803f80
  v_mov_b32 v164, 0
  v_mov_b32 v165, 0
  v_dot2_f32_bf16 v164, v188, s2, v164
  v_dot2_f32_bf16 v165, v188, v188, v165
  v_dot2_f32_bf16 v164, v189, s2, v164
  v_dot2_f32_bf16 v165, v189, v189, v165
  v_dot2_f32_bf16 v164, v190, s2, v164
  v_dot2_f32_bf16 v165, v190, v190, v165
  v_dot2_f32_bf16 v164, v191, s2, v164
  v_dot2_f32_bf16 v165, v191, v191, v165
  v_and_b32 v166, 31, v186
  s_lshl_b32 s62, s48, 8
  s_add_u32 s62, s62, 157696
  v_lshl_add_u32 v166, v166, 3, s62
  v_mov_b32 v192, v164
  v_mov_b32 v193, v165
  s_nop 0
  v_permlane32_swap_b32 v192, v164
  v_permlane32_swap_b32 v193, v165
  s_nop 0
  v_add_f32 v164, v164, v192
  v_add_f32 v165, v165, v193
  ds_write_b64 v166, v[164:165]
  s_waitcnt vmcnt(0) lgkmcnt(0)
  s_barrier
  s_cmp_lg_u32 s48, 0
  s_cbranch_scc1 L_p3_nf
  v_and_b32 v200, 31, v186
  v_lshrrev_b32 v201, 5, v186
  v_lshlrev_b32 v201, 10, v201
  v_lshl_add_u32 v200, v200, 3, v201
  v_add_u32 v200, 157696, v200
  ds_read_b64 v[192:193], v200 offset:0
  ds_read_b64 v[194:195], v200 offset:256
  ds_read_b64 v[196:197], v200 offset:512
  ds_read_b64 v[198:199], v200 offset:768
  s_lshl_b32 s62, s56, 3
  s_add_u32 s62, s62, s57
  s_lshl_b32 s62, s62, 10
  s_add_u32 s62, s62, 786432
  v_lshlrev_b32 v201, 4, v186
  s_waitcnt lgkmcnt(0)
  v_pk_add_f32 v[192:193], v[192:193], v[194:195]
  v_pk_add_f32 v[196:197], v[196:197], v[198:199]
  v_mov_b32 v194, s51
  v_mov_b32 v195, s51
  v_pk_add_f32 v[192:193], v[192:193], v[196:197]
  buffer_store_dwordx4 v[192:195], v201, s[28:31], s62 offen sc1
  s_nop 1
L_p3_nf:
  v_bfe_u32 v160, v186, 2, 2
  v_lshrrev_b32 v161, 5, v186
  v_lshl_add_u32 v161, v161, 2, v160
  v_lshlrev_b32 v161, 8, v161
  v_xor_b32 v162, s54, v160
  v_lshlrev_b32 v162, 2, v162
  v_bfe_u32 v163, v186, 4, 1
  v_lshl_add_u32 v162, v163, 1, v162
  v_bfe_u32 v163, v186, 1, 1
  v_add_u32 v162, v162, v163
  v_lshl_add_u32 v161, v162, 4, v161
  v_and_b32 v163, 1, v186
  v_lshl_add_u32 v176, v163, 3, v161
  s_add_u32 s62, s54, 0
  s_and_b32 s62, s62, 3
  s_lshl_b32 s63, s62, 12
  v_add_u32 v177, s63, v176
  v_add_u32 v181, 0x10000, v177
  s_lshl_b32 s62, s62, 2
  s_lshl_b32 s63, s53, 1
  s_add_u32 s62, s62, s63
  s_lshl_b32 s62, s62, 10
  v_lshl_add_u32 v160, v186, 4, s62
  v_add_u32 v164, 0x10000, v160
  s_add_u32 s62, s54, 1
  s_and_b32 s62, s62, 3
  s_lshl_b32 s63, s62, 12
  v_add_u32 v178, s63, v176
  v_add_u32 v182, 0x10000, v178
  s_lshl_b32 s62, s62, 2
  s_lshl_b32 s63, s53, 1
  s_add_u32 s62, s62, s63
  s_lshl_b32 s62, s62, 10
  v_lshl_add_u32 v161, v186, 4, s62
  v_add_u32 v165, 0x10000, v161
  s_add_u32 s62, s54, 2
  s_and_b32 s62, s62, 3
  s_lshl_b32 s63, s62, 12
  v_add_u32 v179, s63, v176
  v_add_u32 v183, 0x10000, v179
  s_lshl_b32 s62, s62, 2
  s_lshl_b32 s63, s53, 1
  s_add_u32 s62, s62, s63
  s_lshl_b32 s62, s62, 10
  v_lshl_add_u32 v162, v186, 4, s62
  v_add_u32 v166, 0x10000, v162
  s_add_u32 s62, s54, 3
  s_and_b32 s62, s62, 3
  s_lshl_b32 s63, s62, 12
  v_add_u32 v180, s63, v176
  v_add_u32 v184, 0x10000, v180
  s_lshl_b32 s62, s62, 2
  s_lshl_b32 s63, s53, 1
  s_add_u32 s62, s62, s63
  s_lshl_b32 s62, s62, 10
  v_lshl_add_u32 v163, v186, 4, s62
  v_add_u32 v167, 0x10000, v163
  ds_read_b64_tr_b16 v[0:1], v177 offset:0
  ds_read_b64_tr_b16 v[2:3], v177 offset:2048
  ds_read_b64_tr_b16 v[4:5], v178 offset:0
  ds_read_b64_tr_b16 v[6:7], v178 offset:2048
  ds_read_b64_tr_b16 v[8:9], v179 offset:0
  ds_read_b64_tr_b16 v[10:11], v179 offset:2048
  ds_read_b64_tr_b16 v[12:13], v180 offset:0
  ds_read_b64_tr_b16 v[14:15], v180 offset:2048
  ds_read_b64_tr_b16 v[16:17], v177 offset:16384
  ds_read_b64_tr_b16 v[18:19], v177 offset:18432
  ds_read_b64_tr_b16 v[20:21], v178 offset:16384
  ds_read_b64_tr_b16 v[22:23], v178 offset:18432
  ds_read_b64_tr_b16 v[24:25], v179 offset:16384
  ds_read_b64_tr_b16 v[26:27], v179 offset:18432
  ds_read_b64_tr_b16 v[28:29], v180 offset:16384
  ds_read_b64_tr_b16 v[30:31], v180 offset:18432
  ds_read_b64_tr_b16 v[32:33], v177 offset:32768
  ds_read_b64_tr_b16 v[34:35], v177 offset:34816
  ds_read_b64_tr_b16 v[36:37], v178 offset:32768
  ds_read_b64_tr_b16 v[38:39], v178 offset:34816
  ds_read_b64_tr_b16 v[40:41], v179 offset:32768
  ds_read_b64_tr_b16 v[42:43], v179 offset:34816
  ds_read_b64_tr_b16 v[44:45], v180 offset:32768
  ds_read_b64_tr_b16 v[46:47], v180 offset:34816
  ds_read_b64_tr_b16 v[48:49], v177 offset:49152
  ds_read_b64_tr_b16 v[50:51], v177 offset:51200
  ds_read_b64_tr_b16 v[52:53], v178 offset:49152
  ds_read_b64_tr_b16 v[54:55], v178 offset:51200
  ds_read_b64_tr_b16 v[56:57], v179 offset:49152
  ds_read_b64_tr_b16 v[58:59], v179 offset:51200
  ds_read_b64_tr_b16 v[60:61], v180 offset:49152
  ds_read_b64_tr_b16 v[62:63], v180 offset:51200
  ds_read_b64_tr_b16 v[64:65], v181 offset:0
  ds_read_b64_tr_b16 v[66:67], v181 offset:2048
  ds_read_b64_tr_b16 v[68:69], v182 offset:0
  ds_read_b64_tr_b16 v[70:71], v182 offset:2048
  ds_read_b64_tr_b16 v[72:73], v183 offset:0
  ds_read_b64_tr_b16 v[74:75], v183 offset:2048
  ds_read_b64_tr_b16 v[76:77], v184 offset:0
  ds_read_b64_tr_b16 v[78:79], v184 offset:2048
  ds_read_b64_tr_b16 v[80:81], v181 offset:16384
  ds_read_b64_tr_b16 v[82:83], v181 offset:18432
  ds_read_b64_tr_b16 v[84:85], v182 offset:16384
  ds_read_b64_tr_b16 v[86:87], v182 offset:18432
  ds_read_b64_tr_b16 v[88:89], v183 offset:16384
  ds_read_b64_tr_b16 v[90:91], v183 offset:18432
  ds_read_b64_tr_b16 v[92:93], v184 offset:16384
  ds_read_b64_tr_b16 v[94:95], v184 offset:18432
  ds_read_b64_tr_b16 v[96:97], v181 offset:32768
  ds_read_b64_tr_b16 v[98:99], v181 offset:34816
  ds_read_b64_tr_b16 v[100:101], v182 offset:32768
  ds_read_b64_tr_b16 v[102:103], v182 offset:34816
  ds_read_b64_tr_b16 v[104:105], v183 offset:32768
  ds_read_b64_tr_b16 v[106:107], v183 offset:34816
  ds_read_b64_tr_b16 v[108:109], v184 offset:32768
  ds_read_b64_tr_b16 v[110:111], v184 offset:34816
  ds_read_b64_tr_b16 v[112:113], v181 offset:49152
  ds_read_b64_tr_b16 v[114:115], v181 offset:51200
  ds_read_b64_tr_b16 v[116:117], v182 offset:49152
  ds_read_b64_tr_b16 v[118:119], v182 offset:51200
  ds_read_b64_tr_b16 v[120:121], v183 offset:49152
  ds_read_b64_tr_b16 v[122:123], v183 offset:51200
  ds_read_b64_tr_b16 v[124:125], v184 offset:49152
  ds_read_b64_tr_b16 v[126:127], v184 offset:51200
  s_lshl_b32 s6, s54, 11
  s_lshl_b32 s63, s53, 10
  s_add_u32 s6, s6, s63
  s_mul_i32 s100, s54, 458752
  s_and_b32 s101, s56, 3
  s_lshl_b32 s101, s101, 1
  s_add_u32 s101, s101, s57
  s_cmp_ge_u32 s101, 7
  s_cselect_b32 s63, 7, 0
  s_sub_u32 s101, s101, s63
  s_cmp_ge_u32 s50, 28
  s_cbranch_scc1 L_p4_skip
  s_mov_b32 s2, 0x3f803f80
  v_lshrrev_b32 v170, 5, v186
  v_lshlrev_b32 v170, 3, v170
  s_lshl_b32 s62, s59, 2
  s_add_u32 s62, s62, s54
  s_lshl_b32 s62, s62, 6
  buffer_load_dwordx2 v[176:177], v170, s[36:39], s62 offen offset:0
  buffer_load_dwordx2 v[178:179], v170, s[36:39], s62 offen offset:16
  buffer_load_dwordx2 v[180:181], v170, s[36:39], s62 offen offset:32
  buffer_load_dwordx2 v[182:183], v170, s[36:39], s62 offen offset:48
  s_lshl_b32 s62, s58, 4
  s_lshl_b32 s63, s48, 1
  s_add_u32 s62, s62, s63
  s_lshl_b32 s62, s62, 10
  s_add_u32 s62, s62, 786432
  v_lshl_add_u32 v170, v186, 4, s62
  v_mov_b32 v224, 0x3f803f80
  v_mov_b32 v225, 0x3f803f80
  v_and_b32 v240, 31, v186
  s_waitcnt lgkmcnt(0)
  v_mfma_f32_4x4x4_16b_bf16 v[228:231], v[224:225], v[0:1], 0
  v_mfma_f32_4x4x4_16b_bf16 v[232:235], v[224:225], v[2:3], 0
  v_mfma_f32_4x4x4_16b_bf16 v[236:239], v[224:225], v[4:5], 0
  v_mfma_f32_4x4x4_16b_bf16 v[228:231], v[224:225], v[6:7], v[228:231]
  v_mfma_f32_4x4x4_16b_bf16 v[232:235], v[224:225], v[8:9], v[232:235]
  v_mfma_f32_4x4x4_16b_bf16 v[236:239], v[224:225], v[10:11], v[236:239]
  v_mfma_f32_4x4x4_16b_bf16 v[228:231], v[224:225], v[12:13], v[228:231]
  v_mfma_f32_4x4x4_16b_bf16 v[232:235], v[224:225], v[14:15], v[232:235]
  v_mfma_f32_4x4x4_16b_bf16 v[236:239], v[224:225], v[16:17], v[236:239]
  v_mfma_f32_4x4x4_16b_bf16 v[228:231], v[224:225], v[18:19], v[228:231]
  v_mfma_f32_4x4x4_16b_bf16 v[232:235], v[224:225], v[20:21], v[232:235]
  v_mfma_f32_4x4x4_16b_bf16 v[236:239], v[224:225], v[22:23], v[236:239]
  v_mfma_f32_4x4x4_16b_bf16 v[228:231], v[224:225], v[24:25], v[228:231]
  v_mfma_f32_4x4x4_16b_bf16 v[232:235], v[224:225], v[26:27], v[232:235]
  v_mfma_f32_4x4x4_16b_bf16 v[236:239], v[224:225], v[28:29], v[236:239]
  v_mfma_f32_4x4x4_16b_bf16 v[228:231], v[224:225], v[30:31], v[228:231]
  v_mfma_f32_4x4x4_16b_bf16 v[232:235], v[224:225], v[32:33], v[232:235]
  v_mfma_f32_4x4x4_16b_bf16 v[236:239], v[224:225], v[34:35], v[236:239]
  v_mfma_f32_4x4x4_16b_bf16 v[228:231], v[224:225], v[36:37], v[228:231]
  v_mfma_f32_4x4x4_16b_bf16 v[232:235], v[224:225], v[38:39], v[232:235]
  v_mfma_f32_4x4x4_16b_bf16 v[236:239], v[224:225], v[40:41], v[236:239]
  v_mfma_f32_4x4x4_16b_bf16 v[228:231], v[224:225], v[42:43], v[228:231]
  v_mfma_f32_4x4x4_16b_bf16 v[232:235], v[224:225], v[44:45], v[232:235]
  v_mfma_f32_4x4x4_16b_bf16 v[236:239], v[224:225], v[46:47], v[236:239]
  v_mfma_f32_4x4x4_16b_bf16 v[228:231], v[224:225], v[48:49], v[228:231]
  v_mfma_f32_4x4x4_16b_bf16 v[232:235], v[224:225], v[50:51], v[232:235]
  v_mfma_f32_4x4x4_16b_bf16 v[236:239], v[224:225], v[52:53], v[236:239]
  v_mfma_f32_4x4x4_16b_bf16 v[228:231], v[224:225], v[54:55], v[228:231]
  v_mfma_f32_4x4x4_16b_bf16 v[232:235], v[224:225], v[56:57], v[232:235]
  v_mfma_f32_4x4x4_16b_bf16 v[236:239], v[224:225], v[58:59], v[236:239]
  v_mfma_f32_4x4x4_16b_bf16 v[228:231], v[224:225], v[60:61], v[228:231]
  v_mfma_f32_4x4x4_16b_bf16 v[232:235], v[224:225], v[62:63], v[232:235]
  v_mfma_f32_4x4x4_16b_bf16 v[236:239], v[224:225], v[64:65], v[236:239]
  v_mfma_f32_4x4x4_16b_bf16 v[228:231], v[224:225], v[66:67], v[228:231]
  v_mfma_f32_4x4x4_16b_bf16 v[232:235], v[224:225], v[68:69], v[232:235]
  v_mfma_f32_4x4x4_16b_bf16 v[236:239], v[224:225], v[70:71], v[236:239]
  v_mfma_f32_4x4x4_16b_bf16 v[228:231], v[224:225], v[72:73], v[228:231]
  v_mfma_f32_4x4x4_16b_bf16 v[232:235], v[224:225], v[74:75], v[232:235]
  v_mfma_f32_4x4x4_16b_bf16 v[236:239], v[224:225], v[76:77], v[236:239]
  v_mfma_f32_4x4x4_16b_bf16 v[228:231], v[224:225], v[78:79], v[228:231]
  v_mfma_f32_4x4x4_16b_bf16 v[232:235], v[224:225], v[80:81], v[232:235]
  v_mfma_f32_4x4x4_16b_bf16 v[236:239], v[224:225], v[82:83], v[236:239]
  v_mfma_f32_4x4x4_16b_bf16 v[228:231], v[224:225], v[84:85], v[228:231]
  v_mfma_f32_4x4x4_16b_bf16 v[232:235], v[224:225], v[86:87], v[232:235]
  v_mfma_f32_4x4x4_16b_bf16 v[236:239], v[224:225], v[88:89], v[236:239]
  v_mfma_f32_4x4x4_16b_bf16 v[228:231], v[224:225], v[90:91], v[228:231]
  v_mfma_f32_4x4x4_16b_bf16 v[232:235], v[224:225], v[92:93], v[232:235]
  v_mfma_f32_4x4x4_16b_bf16 v[236:239], v[224:225], v[94:95], v[236:239]
  v_mfma_f32_4x4x4_16b_bf16 v[228:231], v[224:225], v[96:97], v[228:231]
  v_mfma_f32_4x4x4_16b_bf16 v[232:235], v[224:225], v[98:99], v[232:235]
  v_mfma_f32_4x4x4_16b_bf16 v[236:239], v[224:225], v[100:101], v[236:239]
  v_mfma_f32_4x4x4_16b_bf16 v[228:231], v[224:225], v[102:103], v[228:231]
  v_mfma_f32_4x4x4_16b_bf16 v[232:235], v[224:225], v[104:105], v[232:235]
  v_mfma_f32_4x4x4_16b_bf16 v[236:239], v[224:225], v[106:107], v[236:239]
  v_mfma_f32_4x4x4_16b_bf16 v[228:231], v[224:225], v[108:109], v[228:231]
  v_mfma_f32_4x4x4_16b_bf16 v[232:235], v[224:225], v[110:111], v[232:235]
  v_mfma_f32_4x4x4_16b_bf16 v[236:239], v[224:225], v[112:113], v[236:239]
  v_mfma_f32_4x4x4_16b_bf16 v[228:231], v[224:225], v[114:115], v[228:231]
  v_mfma_f32_4x4x4_16b_bf16 v[232:235], v[224:225], v[116:117], v[232:235]
  v_mfma_f32_4x4x4_16b_bf16 v[236:239], v[224:225], v[118:119], v[236:239]
  v_mfma_f32_4x4x4_16b_bf16 v[228:231], v[224:225], v[120:121], v[228:231]
  v_mfma_f32_4x4x4_16b_bf16 v[232:235], v[224:225], v[122:123], v[232:235]
  v_mfma_f32_4x4x4_16b_bf16 v[236:239], v[224:225], v[124:125], v[236:239]
  v_mfma_f32_4x4x4_16b_bf16 v[228:231], v[224:225], v[126:127], v[228:231]
  s_lshl_b32 s62, s48, 7
  s_add_u32 s62, s62, 161792
  s_nop 3
  v_add_f32 v228, v228, v232
  v_add_f32 v228, v228, v236
  v_mov_b32 v229, v228
  s_nop 1
  v_permlane32_swap_b32 v229, v228
  s_nop 1
  v_add_f32 v228, v228, v229
  v_lshl_add_u32 v240, v240, 2, s62
  ds_write_b32 v240, v228
  v_lshrrev_b32 v240, 5, v186
  v_lshl_add_u32 v185, v240, 4, s62
  s_mov_b32 s55, 0x40000
L_p4_poll:
  buffer_load_dwordx4 v[192:195], v170, s[28:31], 0 offen sc1
  buffer_load_dwordx4 v[196:199], v170, s[28:31], 0 offen offset:1024 sc1
  s_waitcnt vmcnt(0)
  v_cmp_ne_u32 vcc, s51, v194
  v_cmp_ne_u32 s[4:5], s51, v198
  s_nop 1
  s_or_b64 vcc, vcc, s[4:5]
  s_cbranch_vccz L_p4_pd
  s_sleep 2
  s_sub_u32 s55, s55, 1
  s_cmp_lg_u32 s55, 0
  s_cbranch_scc1 L_p4_poll
  s_mov_b32 s99, 1
L_p4_pd:
  v_pk_add_f32 v[192:193], v[192:193], v[196:197]
  s_lshl_b32 s62, s53, 10
  s_lshl_b32 s63, s54, 2
  s_add_u32 s62, s62, s63
  s_add_u32 s62, s62, 155648
  v_lshl_add_u32 v170, v186, 4, s62
  ds_write_b32 v170, v192
  ds_write_b32 v170, v193 offset:4096
  s_waitcnt lgkmcnt(0)
  s_barrier
  s_lshl_b32 s62, s58, 2
  s_and_b32 s63, s48, 1
  s_lshl_b32 s63, s63, 1
  s_add_u32 s62, s62, s63
  s_lshl_b32 s62, s62, 5
  s_lshr_b32 s63, s48, 1
  s_add_u32 s62, s62, s63
  s_lshl_b32 s62, s62, 10
  s_add_u32 s62, s62, 9437184
  v_lshlrev_b32 v170, 4, v186
  v_add_u32 v171, 32768, v170
  s_mov_b32 s61, s62
  v_mov_b32 v184, v170
  s_add_u32 s2, s7, 0
  s_and_b32 s2, s2, 7
  s_lshl_b32 s2, s2, 12
  s_add_u32 s2, s2, s61
  s_add_u32 m0, s52, 0
  s_nop 0
  buffer_load_dwordx4 v184, s[28:31], s2 offen sc1 lds
  s_add_u32 s2, s2, 32768
  s_add_u32 m0, s52, 1024
  s_nop 0
  buffer_load_dwordx4 v184, s[28:31], s2 offen sc1 lds
  s_add_u32 s2, s7, 1
  s_and_b32 s2, s2, 7
  s_lshl_b32 s2, s2, 12
  s_add_u32 s2, s2, s61
  s_add_u32 m0, s52, 16384
  s_nop 0
  buffer_load_dwordx4 v184, s[28:31], s2 offen sc1 lds
  s_add_u32 s2, s2, 32768
  s_add_u32 m0, s52, 17408
  s_nop 0
  buffer_load_dwordx4 v184, s[28:31], s2 offen sc1 lds
  s_add_u32 s2, s7, 2
  s_and_b32 s2, s2, 7
  s_lshl_b32 s2, s2, 12
  s_add_u32 s2, s2, s61
  s_add_u32 m0, s52, 32768
  s_nop 0
  buffer_load_dwordx4 v184, s[28:31], s2 offen sc1 lds
  s_add_u32 s2, s2, 32768
  s_add_u32 m0, s52, 33792
  s_nop 0
  buffer_load_dwordx4 v184, s[28:31], s2 offen sc1 lds
  v_and_b32 v240, 31, v186
  s_lshl_b32 s62, s53, 10
  s_add_u32 s62, s62, 155648
  v_lshl_add_u32 v241, v240, 4, s62
  ds_read_b128 v[224:227], v241 offset:0
  ds_read_b128 v[232:235], v241 offset:4096
  ds_read_b128 v[228:231], v241 offset:512
  ds_read_b128 v[236:239], v241 offset:4608
  s_waitcnt lgkmcnt(0)
  v_add_f32 v224, v224, v225
  v_add_f32 v226, v226, v227
  v_add_f32 v232, v232, v233
  v_add_f32 v234, v234, v235
  v_add_f32 v224, v224, v226
  v_add_f32 v232, v232, v234
  v_mul_f32 v168, 0x3b000000, v224
  v_mul_f32 v232, 0x3b000000, v232
  v_fma_f32 v232, -v168, v168, v232
  v_max_f32 v232, 0, v232
  v_add_f32 v232, 0x3727c5ac, v232
  v_rsq_f32 v170, v232
  v_add_f32 v228, v228, v229
  v_add_f32 v230, v230, v231
  v_add_f32 v236, v236, v237
  v_add_f32 v238, v238, v239
  v_add_f32 v228, v228, v230
  v_add_f32 v236, v236, v238
  v_mul_f32 v169, 0x3b000000, v228
  v_mul_f32 v236, 0x3b000000, v236
  v_fma_f32 v236, -v169, v169, v236
  v_max_f32 v236, 0, v236
  v_add_f32 v236, 0x3727c5ac, v236
  v_rsq_f32 v171, v236
  s_waitcnt vmcnt(2)
  s_barrier
  ds_read_b128 v[192:195], v160 offset:0
  ds_read_b128 v[196:199], v160 offset:1024
  ds_read_b128 v[200:203], v161 offset:0
  ds_read_b128 v[204:207], v161 offset:1024
  ds_read_b128 v[208:211], v162 offset:0
  ds_read_b128 v[212:215], v162 offset:1024
  ds_read_b128 v[216:219], v163 offset:0
  ds_read_b128 v[220:223], v163 offset:1024
  s_waitcnt lgkmcnt(0)
  v_mfma_f32_32x32x16_bf16 v[128:143], v[0:3], v[192:195], 0
  ds_read_b128 v[224:227], v160 offset:16384
  ds_read_b128 v[228:231], v160 offset:17408
  s_add_u32 s2, s7, 3
  s_and_b32 s2, s2, 7
  s_lshl_b32 s2, s2, 12
  s_add_u32 s2, s2, s61
  s_add_u32 m0, s52, 49152
  s_nop 0
  buffer_load_dwordx4 v184, s[28:31], s2 offen sc1 lds
  v_mfma_f32_32x32x16_bf16 v[144:159], v[0:3], v[196:199], 0
  ds_read_b128 v[232:235], v161 offset:16384
  ds_read_b128 v[236:239], v161 offset:17408
  s_add_u32 s2, s2, 32768
  s_add_u32 m0, s52, 50176
  s_nop 0
  buffer_load_dwordx4 v184, s[28:31], s2 offen sc1 lds
  v_mfma_f32_32x32x16_bf16 v[128:143], v[4:7], v[200:203], v[128:143]
  ds_read_b128 v[240:243], v162 offset:16384
  ds_read_b128 v[244:247], v162 offset:17408
  s_add_u32 s2, s7, 4
  s_and_b32 s2, s2, 7
  s_lshl_b32 s2, s2, 12
  s_add_u32 s2, s2, s61
  s_add_u32 m0, s52, 65536
  s_nop 0
  buffer_load_dwordx4 v184, s[28:31], s2 offen sc1 lds
  v_mfma_f32_32x32x16_bf16 v[144:159], v[4:7], v[204:207], v[144:159]
  ds_read_b128 v[248:251], v163 offset:16384
  ds_read_b128 v[252:255], v163 offset:17408
  s_add_u32 s2, s2, 32768
  s_add_u32 m0, s52, 66560
  s_nop 0
  buffer_load_dwordx4 v184, s[28:31], s2 offen sc1 lds
  v_mfma_f32_32x32x16_bf16 v[128:143], v[8:11], v[208:211], v[128:143]
  v_mfma_f32_32x32x16_bf16 v[144:159], v[8:11], v[212:215], v[144:159]
  v_mfma_f32_32x32x16_bf16 v[128:143], v[12:15], v[216:219], v[128:143]
  v_mfma_f32_32x32x16_bf16 v[144:159], v[12:15], v[220:223], v[144:159]
  s_waitcnt lgkmcnt(0)
  s_waitcnt vmcnt(4)
  s_barrier
  v_mfma_f32_32x32x16_bf16 v[128:143], v[16:19], v[224:227], v[128:143]
  ds_read_b128 v[192:195], v160 offset:32768
  ds_read_b128 v[196:199], v160 offset:33792
  s_add_u32 s2, s7, 5
  s_and_b32 s2, s2, 7
  s_lshl_b32 s2, s2, 12
  s_add_u32 s2, s2, s61
  s_add_u32 m0, s52, 81920
  s_nop 0
  buffer_load_dwordx4 v184, s[28:31], s2 offen sc1 lds
  v_mfma_f32_32x32x16_bf16 v[144:159], v[16:19], v[228:231], v[144:159]
  ds_read_b128 v[200:203], v161 offset:32768
  ds_read_b128 v[204:207], v161 offset:33792
  s_add_u32 s2, s2, 32768
  s_add_u32 m0, s52, 82944
  s_nop 0
  buffer_load_dwordx4 v184, s[28:31], s2 offen sc1 lds
  v_mfma_f32_32x32x16_bf16 v[128:143], v[20:23], v[232:235], v[128:143]
  ds_read_b128 v[208:211], v162 offset:32768
  ds_read_b128 v[212:215], v162 offset:33792
  s_add_u32 s2, s7, 6
  s_and_b32 s2, s2, 7
  s_lshl_b32 s2, s2, 12
  s_add_u32 s2, s2, s61
  s_add_u32 m0, s52, 98304
  s_nop 0
  buffer_load_dwordx4 v184, s[28:31], s2 offen sc1 lds
  v_mfma_f32_32x32x16_bf16 v[144:159], v[20:23], v[236:239], v[144:159]
  ds_read_b128 v[216:219], v163 offset:32768
  ds_read_b128 v[220:223], v163 offset:33792
  s_add_u32 s2, s2, 32768
  s_add_u32 m0, s52, 99328
  s_nop 0
  buffer_load_dwordx4 v184, s[28:31], s2 offen sc1 lds
  v_mfma_f32_32x32x16_bf16 v[128:143], v[24:27], v[240:243], v[128:143]
  s_add_u32 s2, s7, 7
  s_and_b32 s2, s2, 7
  s_lshl_b32 s2, s2, 12
  s_add_u32 s2, s2, s61
  s_add_u32 m0, s52, 114688
  s_nop 0
  buffer_load_dwordx4 v184, s[28:31], s2 offen sc1 lds
  v_mfma_f32_32x32x16_bf16 v[144:159], v[24:27], v[244:247], v[144:159]
  s_add_u32 s2, s2, 32768
  s_add_u32 m0, s52, 115712
  s_nop 0
  buffer_load_dwordx4 v184, s[28:31], s2 offen sc1 lds
  v_mfma_f32_32x32x16_bf16 v[128:143], v[28:31], v[248:251], v[128:143]
  v_mfma_f32_32x32x16_bf16 v[144:159], v[28:31], v[252:255], v[144:159]
  s_waitcnt lgkmcnt(0)
  s_waitcnt vmcnt(6)
  s_barrier
  v_mfma_f32_32x32x16_bf16 v[128:143], v[32:35], v[192:195], v[128:143]
  ds_read_b128 v[224:227], v160 offset:49152
  ds_read_b128 v[228:231], v160 offset:50176
  v_mfma_f32_32x32x16_bf16 v[144:159], v[32:35], v[196:199], v[144:159]
  ds_read_b128 v[232:235], v161 offset:49152
  ds_read_b128 v[236:239], v161 offset:50176
  v_mfma_f32_32x32x16_bf16 v[128:143], v[36:39], v[200:203], v[128:143]
  ds_read_b128 v[240:243], v162 offset:49152
  ds_read_b128 v[244:247], v162 offset:50176
  v_mfma_f32_32x32x16_bf16 v[144:159], v[36:39], v[204:207], v[144:159]
  ds_read_b128 v[248:251], v163 offset:49152
  ds_read_b128 v[252:255], v163 offset:50176
  v_mfma_f32_32x32x16_bf16 v[128:143], v[40:43], v[208:211], v[128:143]
  v_mfma_f32_32x32x16_bf16 v[144:159], v[40:43], v[212:215], v[144:159]
  v_mfma_f32_32x32x16_bf16 v[128:143], v[44:47], v[216:219], v[128:143]
  v_mfma_f32_32x32x16_bf16 v[144:159], v[44:47], v[220:223], v[144:159]
  s_waitcnt lgkmcnt(0)
  v_mfma_f32_32x32x16_bf16 v[128:143], v[48:51], v[224:227], v[128:143]
  ds_read_b128 v[192:195], v164 offset:0
  ds_read_b128 v[196:199], v164 offset:1024
  v_mfma_f32_32x32x16_bf16 v[144:159], v[48:51], v[228:231], v[144:159]
  ds_read_b128 v[200:203], v165 offset:0
  ds_read_b128 v[204:207], v165 offset:1024
  v_mfma_f32_32x32x16_bf16 v[128:143], v[52:55], v[232:235], v[128:143]
  ds_read_b128 v[208:211], v166 offset:0
  ds_read_b128 v[212:215], v166 offset:1024
  v_mfma_f32_32x32x16_bf16 v[144:159], v[52:55], v[236:239], v[144:159]
  ds_read_b128 v[216:219], v167 offset:0
  ds_read_b128 v[220:223], v167 offset:1024
  v_mfma_f32_32x32x16_bf16 v[128:143], v[56:59], v[240:243], v[128:143]
  v_mfma_f32_32x32x16_bf16 v[144:159], v[56:59], v[244:247], v[144:159]
  v_mfma_f32_32x32x16_bf16 v[128:143], v[60:63], v[248:251], v[128:143]
  v_mfma_f32_32x32x16_bf16 v[144:159], v[60:63], v[252:255], v[144:159]
  s_waitcnt lgkmcnt(0)
  s_waitcnt vmcnt(0)
  s_barrier
  v_mfma_f32_32x32x16_bf16 v[128:143], v[64:67], v[192:195], v[128:143]
  ds_read_b128 v[224:227], v164 offset:16384
  ds_read_b128 v[228:231], v164 offset:17408
  v_mfma_f32_32x32x16_bf16 v[144:159], v[64:67], v[196:199], v[144:159]
  ds_read_b128 v[232:235], v165 offset:16384
  ds_read_b128 v[236:239], v165 offset:17408
  s_add_u32 s63, s101, 0
  s_cmp_ge_u32 s63, 7
  s_cselect_b32 s55, 7, 0
  s_sub_u32 s63, s63, s55
  s_lshl_b32 s63, s63, 16
  s_add_u32 s63, s63, s100
  s_add_u32 s63, s63, 0
  s_add_u32 m0, s6, 131072
  s_nop 0
  buffer_load_dwordx4 v172, s[24:27], s63 offen lds
  v_mfma_f32_32x32x16_bf16 v[128:143], v[68:71], v[200:203], v[128:143]
  ds_read_b128 v[240:243], v166 offset:16384
  ds_read_b128 v[244:247], v166 offset:17408
  v_mfma_f32_32x32x16_bf16 v[144:159], v[68:71], v[204:207], v[144:159]
  ds_read_b128 v[248:251], v167 offset:16384
  ds_read_b128 v[252:255], v167 offset:17408
  s_add_u32 s63, s101, 0
  s_cmp_ge_u32 s63, 7
  s_cselect_b32 s55, 7, 0
  s_sub_u32 s63, s63, s55
  s_lshl_b32 s63, s63, 16
  s_add_u32 s63, s63, s100
  s_add_u32 s63, s63, 16384
  s_add_u32 m0, s6, 139264
  s_nop 0
  buffer_load_dwordx4 v172, s[24:27], s63 offen lds
  v_mfma_f32_32x32x16_bf16 v[128:143], v[72:75], v[208:211], v[128:143]
  v_mfma_f32_32x32x16_bf16 v[144:159], v[72:75], v[212:215], v[144:159]
  s_add_u32 s63, s101, 0
  s_cmp_ge_u32 s63, 7
  s_cselect_b32 s55, 7, 0
  s_sub_u32 s63, s63, s55
  s_lshl_b32 s63, s63, 16
  s_add_u32 s63, s63, s100
  s_add_u32 s63, s63, 32768
  s_add_u32 m0, s6, 147456
  s_nop 0
  buffer_load_dwordx4 v172, s[24:27], s63 offen lds
  v_mfma_f32_32x32x16_bf16 v[128:143], v[76:79], v[216:219], v[128:143]
  v_mfma_f32_32x32x16_bf16 v[144:159], v[76:79], v[220:223], v[144:159]
  s_add_u32 s63, s101, 0
  s_cmp_ge_u32 s63, 7
  s_cselect_b32 s55, 7, 0
  s_sub_u32 s63, s63, s55
  s_lshl_b32 s63, s63, 16
  s_add_u32 s63, s63, s100
  s_add_u32 s63, s63, 49152
  s_add_u32 m0, s6, 0
  s_nop 0
  buffer_load_dwordx4 v172, s[24:27], s63 offen lds
  s_waitcnt lgkmcnt(0)
  v_mfma_f32_32x32x16_bf16 v[128:143], v[80:83], v[224:227], v[128:143]
  ds_read_b128 v[192:195], v164 offset:32768
  ds_read_b128 v[196:199], v164 offset:33792
  v_mfma_f32_32x32x16_bf16 v[144:159], v[80:83], v[228:231], v[144:159]
  ds_read_b128 v[200:203], v165 offset:32768
  ds_read_b128 v[204:207], v165 offset:33792
  s_add_u32 s63, s101, 1
  s_cmp_ge_u32 s63, 7
  s_cselect_b32 s55, 7, 0
  s_sub_u32 s63, s63, s55
  s_lshl_b32 s63, s63, 16
  s_add_u32 s63, s63, s100
  s_add_u32 s63, s63, 0
  s_add_u32 m0, s6, 8192
  s_nop 0
  buffer_load_dwordx4 v172, s[24:27], s63 offen lds
  v_mfma_f32_32x32x16_bf16 v[128:143], v[84:87], v[232:235], v[128:143]
  ds_read_b128 v[208:211], v166 offset:32768
  ds_read_b128 v[212:215], v166 offset:33792
  v_mfma_f32_32x32x16_bf16 v[144:159], v[84:87], v[236:239], v[144:159]
  ds_read_b128 v[216:219], v167 offset:32768
  ds_read_b128 v[220:223], v167 offset:33792
  s_add_u32 s63, s101, 1
  s_cmp_ge_u32 s63, 7
  s_cselect_b32 s55, 7, 0
  s_sub_u32 s63, s63, s55
  s_lshl_b32 s63, s63, 16
  s_add_u32 s63, s63, s100
  s_add_u32 s63, s63, 16384
  s_add_u32 m0, s6, 16384
  s_nop 0
  buffer_load_dwordx4 v172, s[24:27], s63 offen lds
  v_mfma_f32_32x32x16_bf16 v[128:143], v[88:91], v[240:243], v[128:143]
  v_mfma_f32_32x32x16_bf16 v[144:159], v[88:91], v[244:247], v[144:159]
  s_add_u32 s63, s101, 1
  s_cmp_ge_u32 s63, 7
  s_cselect_b32 s55, 7, 0
  s_sub_u32 s63, s63, s55
  s_lshl_b32 s63, s63, 16
  s_add_u32 s63, s63, s100
  s_add_u32 s63, s63, 32768
  s_add_u32 m0, s6, 24576
  s_nop 0
  buffer_load_dwordx4 v172, s[24:27], s63 offen lds
  v_mfma_f32_32x32x16_bf16 v[128:143], v[92:95], v[248:251], v[128:143]
  v_mfma_f32_32x32x16_bf16 v[144:159], v[92:95], v[252:255], v[144:159]
  s_add_u32 s63, s101, 1
  s_cmp_ge_u32 s63, 7
  s_cselect_b32 s55, 7, 0
  s_sub_u32 s63, s63, s55
  s_lshl_b32 s63, s63, 16
  s_add_u32 s63, s63, s100
  s_add_u32 s63, s63, 49152
  s_add_u32 m0, s6, 32768
  s_nop 0
  buffer_load_dwordx4 v172, s[24:27], s63 offen lds
  s_waitcnt lgkmcnt(0)
  v_mfma_f32_32x32x16_bf16 v[128:143], v[96:99], v[192:195], v[128:143]
  ds_read_b128 v[224:227], v164 offset:49152
  ds_read_b128 v[228:231], v164 offset:50176
  v_mfma_f32_32x32x16_bf16 v[144:159], v[96:99], v[196:199], v[144:159]
  ds_read_b128 v[232:235], v165 offset:49152
  ds_read_b128 v[236:239], v165 offset:50176
  s_add_u32 s63, s101, 2
  s_cmp_ge_u32 s63, 7
  s_cselect_b32 s55, 7, 0
  s_sub_u32 s63, s63, s55
  s_lshl_b32 s63, s63, 16
  s_add_u32 s63, s63, s100
  s_add_u32 s63, s63, 0
  s_add_u32 m0, s6, 40960
  s_nop 0
  buffer_load_dwordx4 v172, s[24:27], s63 offen lds
  v_mfma_f32_32x32x16_bf16 v[128:143], v[100:103], v[200:203], v[128:143]
  ds_read_b128 v[240:243], v166 offset:49152
  ds_read_b128 v[244:247], v166 offset:50176
  v_mfma_f32_32x32x16_bf16 v[144:159], v[100:103], v[204:207], v[144:159]
  ds_read_b128 v[248:251], v167 offset:49152
  ds_read_b128 v[252:255], v167 offset:50176
  s_add_u32 s63, s101, 2
  s_cmp_ge_u32 s63, 7
  s_cselect_b32 s55, 7, 0
  s_sub_u32 s63, s63, s55
  s_lshl_b32 s63, s63, 16
  s_add_u32 s63, s63, s100
  s_add_u32 s63, s63, 16384
  s_add_u32 m0, s6, 49152
  s_nop 0
  buffer_load_dwordx4 v172, s[24:27], s63 offen lds
  v_mfma_f32_32x32x16_bf16 v[128:143], v[104:107], v[208:211], v[128:143]
  v_mfma_f32_32x32x16_bf16 v[144:159], v[104:107], v[212:215], v[144:159]
  s_add_u32 s63, s101, 2
  s_cmp_ge_u32 s63, 7
  s_cselect_b32 s55, 7, 0
  s_sub_u32 s63, s63, s55
  s_lshl_b32 s63, s63, 16
  s_add_u32 s63, s63, s100
  s_add_u32 s63, s63, 32768
  s_add_u32 m0, s6, 57344
  s_nop 0
  buffer_load_dwordx4 v172, s[24:27], s63 offen lds
  v_mfma_f32_32x32x16_bf16 v[128:143], v[108:111], v[216:219], v[128:143]
  v_mfma_f32_32x32x16_bf16 v[144:159], v[108:111], v[220:223], v[144:159]
  s_add_u32 s63, s101, 2
  s_cmp_ge_u32 s63, 7
  s_cselect_b32 s55, 7, 0
  s_sub_u32 s63, s63, s55
  s_lshl_b32 s63, s63, 16
  s_add_u32 s63, s63, s100
  s_add_u32 s63, s63, 49152
  s_add_u32 m0, s6, 65536
  s_nop 0
  buffer_load_dwordx4 v172, s[24:27], s63 offen lds
  s_waitcnt lgkmcnt(0)
  v_mfma_f32_32x32x16_bf16 v[128:143], v[112:115], v[224:227], v[128:143]
  v_mfma_f32_32x32x16_bf16 v[144:159], v[112:115], v[228:231], v[144:159]
  s_add_u32 s63, s101, 3
  s_cmp_ge_u32 s63, 7
  s_cselect_b32 s55, 7, 0
  s_sub_u32 s63, s63, s55
  s_lshl_b32 s63, s63, 16
  s_add_u32 s63, s63, s100
  s_add_u32 s63, s63, 0
  s_add_u32 m0, s6, 73728
  s_nop 0
  buffer_load_dwordx4 v172, s[24:27], s63 offen lds
  v_mfma_f32_32x32x16_bf16 v[128:143], v[116:119], v[232:235], v[128:143]
  v_mfma_f32_32x32x16_bf16 v[144:159], v[116:119], v[236:239], v[144:159]
  v_mfma_f32_32x32x16_bf16 v[128:143], v[120:123], v[240:243], v[128:143]
  v_mfma_f32_32x32x16_bf16 v[144:159], v[120:123], v[244:247], v[144:159]
  v_mfma_f32_32x32x16_bf16 v[128:143], v[124:127], v[248:251], v[128:143]
  v_mfma_f32_32x32x16_bf16 v[144:159], v[124:127], v[252:255], v[144:159]
  ds_read_b128 v[72:75], v185 offset:0
  ds_read_b128 v[76:79], v185 offset:32
  ds_read_b128 v[80:83], v185 offset:64
  ds_read_b128 v[84:87], v185 offset:96
  v_lshlrev_b32 v88, 16, v176
  v_and_b32 v89, 0xffff0000, v176
  v_lshlrev_b32 v90, 16, v177
  v_and_b32 v91, 0xffff0000, v177
  v_lshlrev_b32 v92, 16, v178
  v_and_b32 v93, 0xffff0000, v178
  v_lshlrev_b32 v94, 16, v179
  v_and_b32 v95, 0xffff0000, v179
  v_lshlrev_b32 v96, 16, v180
  v_and_b32 v97, 0xffff0000, v180
  v_lshlrev_b32 v98, 16, v181
  v_and_b32 v99, 0xffff0000, v181
  v_lshlrev_b32 v100, 16, v182
  v_and_b32 v101, 0xffff0000, v182
  v_lshlrev_b32 v102, 16, v183
  v_and_b32 v103, 0xffff0000, v183
  s_lshl_b32 s62, s58, 1
  s_add_u32 s62, s62, s53
  s_lshl_b32 s63, s59, 2
  s_add_u32 s63, s63, s54
  s_lshl_b32 s3, s58, 4
  s_add_u32 s3, s3, s59
  s_lshl_b32 s3, s3, 7
  s_add_u32 s3, s3, 131072
  s_mul_i32 s62, s62, 112
  s_add_u32 s62, s62, s63
  s_lshl_b32 s62, s62, 11
  s_add_u32 s62, s62, 11534336
  s_add_u32 s63, s62, 114688
  v_lshlrev_b32 v120, 4, v186
  s_waitcnt lgkmcnt(0)
  v_pk_fma_f32 v[128:129], v[72:73], v[168:169], v[128:129] op_sel_hi:[1,0,1] neg_lo:[0,1,0] neg_hi:[0,1,0]
  v_pk_fma_f32 v[130:131], v[74:75], v[168:169], v[130:131] op_sel_hi:[1,0,1] neg_lo:[0,1,0] neg_hi:[0,1,0]
  v_pk_fma_f32 v[132:133], v[76:77], v[168:169], v[132:133] op_sel_hi:[1,0,1] neg_lo:[0,1,0] neg_hi:[0,1,0]
  v_pk_fma_f32 v[134:135], v[78:79], v[168:169], v[134:135] op_sel_hi:[1,0,1] neg_lo:[0,1,0] neg_hi:[0,1,0]
  v_pk_fma_f32 v[136:137], v[80:81], v[168:169], v[136:137] op_sel_hi:[1,0,1] neg_lo:[0,1,0] neg_hi:[0,1,0]
  v_pk_fma_f32 v[138:139], v[82:83], v[168:169], v[138:139] op_sel_hi:[1,0,1] neg_lo:[0,1,0] neg_hi:[0,1,0]
  v_pk_fma_f32 v[140:141], v[84:85], v[168:169], v[140:141] op_sel_hi:[1,0,1] neg_lo:[0,1,0] neg_hi:[0,1,0]
  v_pk_fma_f32 v[142:143], v[86:87], v[168:169], v[142:143] op_sel_hi:[1,0,1] neg_lo:[0,1,0] neg_hi:[0,1,0]
  v_pk_fma_f32 v[128:129], v[128:129], v[170:171], v[88:89] op_sel_hi:[1,0,1]
  v_pk_fma_f32 v[130:131], v[130:131], v[170:171], v[90:91] op_sel_hi:[1,0,1]
  v_pk_fma_f32 v[132:133], v[132:133], v[170:171], v[92:93] op_sel_hi:[1,0,1]
  v_pk_fma_f32 v[134:135], v[134:135], v[170:171], v[94:95] op_sel_hi:[1,0,1]
  v_pk_fma_f32 v[136:137], v[136:137], v[170:171], v[96:97] op_sel_hi:[1,0,1]
  v_pk_fma_f32 v[138:139], v[138:139], v[170:171], v[98:99] op_sel_hi:[1,0,1]
  v_pk_fma_f32 v[140:141], v[140:141], v[170:171], v[100:101] op_sel_hi:[1,0,1]
  v_pk_fma_f32 v[142:143], v[142:143], v[170:171], v[102:103] op_sel_hi:[1,0,1]
  v_max_f32 v128, 0, v128
  v_max_f32 v129, 0, v129
  v_max_f32 v130, 0, v130
  v_max_f32 v131, 0, v131
  v_max_f32 v132, 0, v132
  v_max_f32 v133, 0, v133
  v_max_f32 v134, 0, v134
  v_max_f32 v135, 0, v135
  v_max_f32 v136, 0, v136
  v_max_f32 v137, 0, v137
  v_max_f32 v138, 0, v138
  v_max_f32 v139, 0, v139
  v_max_f32 v140, 0, v140
  v_max_f32 v141, 0, v141
  v_max_f32 v142, 0, v142
  v_max_f32 v143, 0, v143
  v_pk_mul_f32 v[128:129], v[128:129], v[128:129]
  v_pk_mul_f32 v[130:131], v[130:131], v[130:131]
  v_pk_mul_f32 v[132:133], v[132:133], v[132:133]
  v_pk_mul_f32 v[134:135], v[134:135], v[134:135]
  v_pk_mul_f32 v[136:137], v[136:137], v[136:137]
  v_pk_mul_f32 v[138:139], v[138:139], v[138:139]
  v_pk_mul_f32 v[140:141], v[140:141], v[140:141]
  v_pk_mul_f32 v[142:143], v[142:143], v[142:143]
  v_cvt_pk_bf16_f32 v104, v128, v129
  v_cvt_pk_bf16_f32 v105, v130, v131
  v_cvt_pk_bf16_f32 v106, v132, v133
  v_cvt_pk_bf16_f32 v107, v134, v135
  v_cvt_pk_bf16_f32 v108, v136, v137
  v_cvt_pk_bf16_f32 v109, v138, v139
  v_cvt_pk_bf16_f32 v110, v140, v141
  v_cvt_pk_bf16_f32 v111, v142, v143
  buffer_store_dwordx4 v[104:107], v120, s[28:31], s62 offen offset:0 sc1
  buffer_store_dwordx4 v[108:111], v120, s[28:31], s62 offen offset:1024 sc1
  v_pk_fma_f32 v[144:145], v[72:73], v[168:169], v[144:145] op_sel:[0,1,0] neg_lo:[0,1,0] neg_hi:[0,1,0]
  v_pk_fma_f32 v[146:147], v[74:75], v[168:169], v[146:147] op_sel:[0,1,0] neg_lo:[0,1,0] neg_hi:[0,1,0]
  v_pk_fma_f32 v[148:149], v[76:77], v[168:169], v[148:149] op_sel:[0,1,0] neg_lo:[0,1,0] neg_hi:[0,1,0]
  v_pk_fma_f32 v[150:151], v[78:79], v[168:169], v[150:151] op_sel:[0,1,0] neg_lo:[0,1,0] neg_hi:[0,1,0]
  v_pk_fma_f32 v[152:153], v[80:81], v[168:169], v[152:153] op_sel:[0,1,0] neg_lo:[0,1,0] neg_hi:[0,1,0]
  v_pk_fma_f32 v[154:155], v[82:83], v[168:169], v[154:155] op_sel:[0,1,0] neg_lo:[0,1,0] neg_hi:[0,1,0]
  v_pk_fma_f32 v[156:157], v[84:85], v[168:169], v[156:157] op_sel:[0,1,0] neg_lo:[0,1,0] neg_hi:[0,1,0]
  v_pk_fma_f32 v[158:159], v[86:87], v[168:169], v[158:159] op_sel:[0,1,0] neg_lo:[0,1,0] neg_hi:[0,1,0]
  v_pk_fma_f32 v[144:145], v[144:145], v[170:171], v[88:89] op_sel:[0,1,0]
  v_pk_fma_f32 v[146:147], v[146:147], v[170:171], v[90:91] op_sel:[0,1,0]
  v_pk_fma_f32 v[148:149], v[148:149], v[170:171], v[92:93] op_sel:[0,1,0]
  v_pk_fma_f32 v[150:151], v[150:151], v[170:171], v[94:95] op_sel:[0,1,0]
  v_pk_fma_f32 v[152:153], v[152:153], v[170:171], v[96:97] op_sel:[0,1,0]
  v_pk_fma_f32 v[154:155], v[154:155], v[170:171], v[98:99] op_sel:[0,1,0]
  v_pk_fma_f32 v[156:157], v[156:157], v[170:171], v[100:101] op_sel:[0,1,0]
  v_pk_fma_f32 v[158:159], v[158:159], v[170:171], v[102:103] op_sel:[0,1,0]
  v_max_f32 v144, 0, v144
  v_max_f32 v145, 0, v145
  v_max_f32 v146, 0, v146
  v_max_f32 v147, 0, v147
  v_max_f32 v148, 0, v148
  v_max_f32 v149, 0, v149
  v_max_f32 v150, 0, v150
  v_max_f32 v151, 0, v151
  v_max_f32 v152, 0, v152
  v_max_f32 v153, 0, v153
  v_max_f32 v154, 0, v154
  v_max_f32 v155, 0, v155
  v_max_f32 v156, 0, v156
  v_max_f32 v157, 0, v157
  v_max_f32 v158, 0, v158
  v_max_f32 v159, 0, v159
  v_pk_mul_f32 v[144:145], v[144:145], v[144:145]
  v_pk_mul_f32 v[146:147], v[146:147], v[146:147]
  v_pk_mul_f32 v[148:149], v[148:149], v[148:149]
  v_pk_mul_f32 v[150:151], v[150:151], v[150:151]
  v_pk_mul_f32 v[152:153], v[152:153], v[152:153]
  v_pk_mul_f32 v[154:155], v[154:155], v[154:155]
  v_pk_mul_f32 v[156:157], v[156:157], v[156:157]
  v_pk_mul_f32 v[158:159], v[158:159], v[158:159]
  v_cvt_pk_bf16_f32 v112, v144, v145
  v_cvt_pk_bf16_f32 v113, v146, v147
  v_cvt_pk_bf16_f32 v114, v148, v149
  v_cvt_pk_bf16_f32 v115, v150, v151
  v_cvt_pk_bf16_f32 v116, v152, v153
  v_cvt_pk_bf16_f32 v117, v154, v155
  v_cvt_pk_bf16_f32 v118, v156, v157
  v_cvt_pk_bf16_f32 v119, v158, v159
  buffer_store_dwordx4 v[112:115], v120, s[28:31], s63 offen offset:0 sc1
  buffer_store_dwordx4 v[116:119], v120, s[28:31], s63 offen offset:1024 sc1
  s_lshl_b32 s62, s54, 11
  v_add_u32 v184, s62, v174
  v_add_u32 v185, s62, v175
  s_waitcnt vmcnt(8)
  s_barrier
  s_branch L_p4_done
L_p4_skip:
  s_mov_b32 s3, 0
  s_waitcnt vmcnt(0)
  s_barrier
  s_add_u32 s63, s101, 0
  s_cmp_ge_u32 s63, 7
  s_cselect_b32 s55, 7, 0
  s_sub_u32 s63, s63, s55
  s_lshl_b32 s63, s63, 16
  s_add_u32 s63, s63, s100
  s_add_u32 s63, s63, 0
  s_add_u32 m0, s6, 131072
  s_nop 0
  buffer_load_dwordx4 v172, s[24:27], s63 offen lds
  s_add_u32 s63, s101, 0
  s_cmp_ge_u32 s63, 7
  s_cselect_b32 s55, 7, 0
  s_sub_u32 s63, s63, s55
  s_lshl_b32 s63, s63, 16
  s_add_u32 s63, s63, s100
  s_add_u32 s63, s63, 16384
  s_add_u32 m0, s6, 139264
  s_nop 0
  buffer_load_dwordx4 v172, s[24:27], s63 offen lds
  s_add_u32 s63, s101, 0
  s_cmp_ge_u32 s63, 7
  s_cselect_b32 s55, 7, 0
  s_sub_u32 s63, s63, s55
  s_lshl_b32 s63, s63, 16
  s_add_u32 s63, s63, s100
  s_add_u32 s63, s63, 32768
  s_add_u32 m0, s6, 147456
  s_nop 0
  buffer_load_dwordx4 v172, s[24:27], s63 offen lds
  s_add_u32 s63, s101, 0
  s_cmp_ge_u32 s63, 7
  s_cselect_b32 s55, 7, 0
  s_sub_u32 s63, s63, s55
  s_lshl_b32 s63, s63, 16
  s_add_u32 s63, s63, s100
  s_add_u32 s63, s63, 49152
  s_add_u32 m0, s6, 0
  s_nop 0
  buffer_load_dwordx4 v172, s[24:27], s63 offen lds
  s_add_u32 s63, s101, 1
  s_cmp_ge_u32 s63, 7
  s_cselect_b32 s55, 7, 0
  s_sub_u32 s63, s63, s55
  s_lshl_b32 s63, s63, 16
  s_add_u32 s63, s63, s100
  s_add_u32 s63, s63, 0
  s_add_u32 m0, s6, 8192
  s_nop 0
  buffer_load_dwordx4 v172, s[24:27], s63 offen lds
  s_add_u32 s63, s101, 1
  s_cmp_ge_u32 s63, 7
  s_cselect_b32 s55, 7, 0
  s_sub_u32 s63, s63, s55
  s_lshl_b32 s63, s63, 16
  s_add_u32 s63, s63, s100
  s_add_u32 s63, s63, 16384
  s_add_u32 m0, s6, 16384
  s_nop 0
  buffer_load_dwordx4 v172, s[24:27], s63 offen lds
  s_add_u32 s63, s101, 1
  s_cmp_ge_u32 s63, 7
  s_cselect_b32 s55, 7, 0
  s_sub_u32 s63, s63, s55
  s_lshl_b32 s63, s63, 16
  s_add_u32 s63, s63, s100
  s_add_u32 s63, s63, 32768
  s_add_u32 m0, s6, 24576
  s_nop 0
  buffer_load_dwordx4 v172, s[24:27], s63 offen lds
  s_add_u32 s63, s101, 1
  s_cmp_ge_u32 s63, 7
  s_cselect_b32 s55, 7, 0
  s_sub_u32 s63, s63, s55
  s_lshl_b32 s63, s63, 16
  s_add_u32 s63, s63, s100
  s_add_u32 s63, s63, 49152
  s_add_u32 m0, s6, 32768
  s_nop 0
  buffer_load_dwordx4 v172, s[24:27], s63 offen lds
  s_add_u32 s63, s101, 2
  s_cmp_ge_u32 s63, 7
  s_cselect_b32 s55, 7, 0
  s_sub_u32 s63, s63, s55
  s_lshl_b32 s63, s63, 16
  s_add_u32 s63, s63, s100
  s_add_u32 s63, s63, 0
  s_add_u32 m0, s6, 40960
  s_nop 0
  buffer_load_dwordx4 v172, s[24:27], s63 offen lds
  s_add_u32 s63, s101, 2
  s_cmp_ge_u32 s63, 7
  s_cselect_b32 s55, 7, 0
  s_sub_u32 s63, s63, s55
  s_lshl_b32 s63, s63, 16
  s_add_u32 s63, s63, s100
  s_add_u32 s63, s63, 16384
  s_add_u32 m0, s6, 49152
  s_nop 0
  buffer_load_dwordx4 v172, s[24:27], s63 offen lds
  s_add_u32 s63, s101, 2
  s_cmp_ge_u32 s63, 7
  s_cselect_b32 s55, 7, 0
  s_sub_u32 s63, s63, s55
  s_lshl_b32 s63, s63, 16
  s_add_u32 s63, s63, s100
  s_add_u32 s63, s63, 32768
  s_add_u32 m0, s6, 57344
  s_nop 0
  buffer_load_dwordx4 v172, s[24:27], s63 offen lds
  s_add_u32 s63, s101, 2
  s_cmp_ge_u32 s63, 7
  s_cselect_b32 s55, 7, 0
  s_sub_u32 s63, s63, s55
  s_lshl_b32 s63, s63, 16
  s_add_u32 s63, s63, s100
  s_add_u32 s63, s63, 49152
  s_add_u32 m0, s6, 65536
  s_nop 0
  buffer_load_dwordx4 v172, s[24:27], s63 offen lds
  s_add_u32 s63, s101, 3
  s_cmp_ge_u32 s63, 7
  s_cselect_b32 s55, 7, 0
  s_sub_u32 s63, s63, s55
  s_lshl_b32 s63, s63, 16
  s_add_u32 s63, s63, s100
  s_add_u32 s63, s63, 0
  s_add_u32 m0, s6, 73728
  s_nop 0
  buffer_load_dwordx4 v172, s[24:27], s63 offen lds
  s_lshl_b32 s62, s54, 11
  v_add_u32 v184, s62, v174
  v_add_u32 v185, s62, v175
  s_waitcnt vmcnt(4)
  s_barrier
  s_mov_b32 s62, 0
  s_mov_b32 s63, 0
L_p4_done:
  v_add_u32 v184, 0x20000, v184
  v_add_u32 v185, 0x20000, v185
  ds_read_b64_tr_b16 v[0:1], v184 offset:0
  ds_read_b64_tr_b16 v[2:3], v184 offset:1024
  ds_read_b64_tr_b16 v[4:5], v185 offset:0
  ds_read_b64_tr_b16 v[6:7], v185 offset:1024
  ds_read_b64_tr_b16 v[8:9], v184 offset:8192
  ds_read_b64_tr_b16 v[10:11], v184 offset:9216
  ds_read_b64_tr_b16 v[12:13], v185 offset:8192
  ds_read_b64_tr_b16 v[14:15], v185 offset:9216
  ds_read_b64_tr_b16 v[16:17], v184 offset:16384
  ds_read_b64_tr_b16 v[18:19], v184 offset:17408
  ds_read_b64_tr_b16 v[20:21], v185 offset:16384
  ds_read_b64_tr_b16 v[22:23], v185 offset:17408
  v_add_u32 v184, 0xfffe0000, v184
  v_add_u32 v185, 0xfffe0000, v185
  ds_read_b64_tr_b16 v[24:25], v184 offset:0
  ds_read_b64_tr_b16 v[26:27], v184 offset:1024
  ds_read_b64_tr_b16 v[28:29], v185 offset:0
  ds_read_b64_tr_b16 v[30:31], v185 offset:1024
  ds_read_b64_tr_b16 v[32:33], v184 offset:8192
  ds_read_b64_tr_b16 v[34:35], v184 offset:9216
  ds_read_b64_tr_b16 v[36:37], v185 offset:8192
  ds_read_b64_tr_b16 v[38:39], v185 offset:9216
  ds_read_b64_tr_b16 v[40:41], v184 offset:16384
  ds_read_b64_tr_b16 v[42:43], v184 offset:17408
  ds_read_b64_tr_b16 v[44:45], v185 offset:16384
  ds_read_b64_tr_b16 v[46:47], v185 offset:17408
  ds_read_b64_tr_b16 v[48:49], v184 offset:24576
  ds_read_b64_tr_b16 v[50:51], v184 offset:25600
  ds_read_b64_tr_b16 v[52:53], v185 offset:24576
  ds_read_b64_tr_b16 v[54:55], v185 offset:25600
  ds_read_b64_tr_b16 v[56:57], v184 offset:32768
  ds_read_b64_tr_b16 v[58:59], v184 offset:33792
  ds_read_b64_tr_b16 v[60:61], v185 offset:32768
  ds_read_b64_tr_b16 v[62:63], v185 offset:33792
  ds_read_b64_tr_b16 v[64:65], v184 offset:40960
  ds_read_b64_tr_b16 v[66:67], v184 offset:41984
  ds_read_b64_tr_b16 v[68:69], v185 offset:40960
  ds_read_b64_tr_b16 v[70:71], v185 offset:41984
  s_waitcnt lgkmcnt(0)
  s_waitcnt vmcnt(0)
  s_barrier
  s_cmp_lg_u32 s48, 0
  s_cbranch_scc1 sf_21
  s_cmp_eq_u32 s3, 0
  s_cbranch_scc1 sf_21
  v_mov_b32 v124, s51
  v_mov_b32 v125, 0
  s_mov_b64 exec, 1
  buffer_store_dword v124, v125, s[28:31], s3 offen sc1
  s_mov_b64 exec, -1
sf_21:
  v_lshrrev_b32 v122, 5, v186
  v_lshlrev_b32 v122, 3, v122
  s_lshl_b32 s62, s57, 2
  s_add_u32 s62, s62, s54
  s_lshl_b32 s3, s62, 5
  buffer_load_dwordx2 v[224:225], v122, s[40:43], s3 offen
  buffer_load_dwordx2 v[226:227], v122, s[40:43], s3 offen offset:16
  s_add_u32 s63, s101, 3
  s_cmp_ge_u32 s63, 7
  s_cselect_b32 s55, 7, 0
  s_sub_u32 s63, s63, s55
  s_lshl_b32 s63, s63, 16
  s_add_u32 s63, s63, s100
  s_add_u32 s63, s63, 16384
  s_add_u32 m0, s6, 81920
  s_nop 0
  buffer_load_dwordx4 v172, s[24:27], s63 offen lds
  s_add_u32 s63, s101, 3
  s_cmp_ge_u32 s63, 7
  s_cselect_b32 s55, 7, 0
  s_sub_u32 s63, s63, s55
  s_lshl_b32 s63, s63, 16
  s_add_u32 s63, s63, s100
  s_add_u32 s63, s63, 32768
  s_add_u32 m0, s6, 90112
  s_nop 0
  buffer_load_dwordx4 v172, s[24:27], s63 offen lds
  s_add_u32 s63, s101, 3
  s_cmp_ge_u32 s63, 7
  s_cselect_b32 s55, 7, 0
  s_sub_u32 s63, s63, s55
  s_lshl_b32 s63, s63, 16
  s_add_u32 s63, s63, s100
  s_add_u32 s63, s63, 49152
  s_add_u32 m0, s6, 98304
  s_nop 0
  buffer_load_dwordx4 v172, s[24:27], s63 offen lds
  s_add_u32 s63, s101, 4
  s_cmp_ge_u32 s63, 7
  s_cselect_b32 s55, 7, 0
  s_sub_u32 s63, s63, s55
  s_lshl_b32 s63, s63, 16
  s_add_u32 s63, s63, s100
  s_add_u32 s63, s63, 0
  s_add_u32 m0, s6, 106496
  s_nop 0
  buffer_load_dwordx4 v172, s[24:27], s63 offen lds
  s_add_u32 s63, s101, 4
  s_cmp_ge_u32 s63, 7
  s_cselect_b32 s55, 7, 0
  s_sub_u32 s63, s63, s55
  s_lshl_b32 s63, s63, 16
  s_add_u32 s63, s63, s100
  s_add_u32 s63, s63, 16384
  s_add_u32 m0, s6, 114688
  s_nop 0
  buffer_load_dwordx4 v172, s[24:27], s63 offen lds
  s_add_u32 s63, s101, 4
  s_cmp_ge_u32 s63, 7
  s_cselect_b32 s55, 7, 0
  s_sub_u32 s63, s63, s55
  s_lshl_b32 s63, s63, 16
  s_add_u32 s63, s63, s100
  s_add_u32 s63, s63, 32768
  s_add_u32 m0, s6, 122880
  s_nop 0
  buffer_load_dwordx4 v172, s[24:27], s63 offen lds
  s_add_u32 s63, s101, 4
  s_cmp_ge_u32 s63, 7
  s_cselect_b32 s55, 7, 0
  s_sub_u32 s63, s63, s55
  s_lshl_b32 s63, s63, 16
  s_add_u32 s63, s63, s100
  s_add_u32 s63, s63, 49152
  s_add_u32 m0, s6, 131072
  s_nop 0
  buffer_load_dwordx4 v172, s[24:27], s63 offen lds
  s_add_u32 s63, s101, 5
  s_cmp_ge_u32 s63, 7
  s_cselect_b32 s55, 7, 0
  s_sub_u32 s63, s63, s55
  s_lshl_b32 s63, s63, 16
  s_add_u32 s63, s63, s100
  s_add_u32 s63, s63, 0
  s_add_u32 m0, s6, 139264
  s_nop 0
  buffer_load_dwordx4 v172, s[24:27], s63 offen lds
  s_add_u32 s63, s101, 5
  s_cmp_ge_u32 s63, 7
  s_cselect_b32 s55, 7, 0
  s_sub_u32 s63, s63, s55
  s_lshl_b32 s63, s63, 16
  s_add_u32 s63, s63, s100
  s_add_u32 s63, s63, 16384
  s_add_u32 m0, s6, 147456
  s_nop 0
  buffer_load_dwordx4 v172, s[24:27], s63 offen lds
  s_add_u32 s63, s101, 5
  s_cmp_ge_u32 s63, 7
  s_cselect_b32 s55, 7, 0
  s_sub_u32 s63, s63, s55
  s_lshl_b32 s63, s63, 16
  s_add_u32 s63, s63, s100
  s_add_u32 s63, s63, 32768
  s_add_u32 m0, s6, 0
  s_nop 0
  buffer_load_dwordx4 v172, s[24:27], s63 offen lds
  s_add_u32 s63, s101, 5
  s_cmp_ge_u32 s63, 7
  s_cselect_b32 s55, 7, 0
  s_sub_u32 s63, s63, s55
  s_lshl_b32 s63, s63, 16
  s_add_u32 s63, s63, s100
  s_add_u32 s63, s63, 49152
  s_add_u32 m0, s6, 8192
  s_nop 0
  buffer_load_dwordx4 v172, s[24:27], s63 offen lds
  s_add_u32 s63, s101, 6
  s_cmp_ge_u32 s63, 7
  s_cselect_b32 s55, 7, 0
  s_sub_u32 s63, s63, s55
  s_lshl_b32 s63, s63, 16
  s_add_u32 s63, s63, s100
  s_add_u32 s63, s63, 0
  s_add_u32 m0, s6, 16384
  s_nop 0
  buffer_load_dwordx4 v172, s[24:27], s63 offen lds
  s_add_u32 s63, s101, 6
  s_cmp_ge_u32 s63, 7
  s_cselect_b32 s55, 7, 0
  s_sub_u32 s63, s63, s55
  s_lshl_b32 s63, s63, 16
  s_add_u32 s63, s63, s100
  s_add_u32 s63, s63, 16384
  s_add_u32 m0, s6, 24576
  s_nop 0
  buffer_load_dwordx4 v172, s[24:27], s63 offen lds
  s_add_u32 s63, s101, 6
  s_cmp_ge_u32 s63, 7
  s_cselect_b32 s55, 7, 0
  s_sub_u32 s63, s63, s55
  s_lshl_b32 s63, s63, 16
  s_add_u32 s63, s63, s100
  s_add_u32 s63, s63, 32768
  s_add_u32 m0, s6, 32768
  s_nop 0
  buffer_load_dwordx4 v172, s[24:27], s63 offen lds
  s_add_u32 s63, s101, 6
  s_cmp_ge_u32 s63, 7
  s_cselect_b32 s55, 7, 0
  s_sub_u32 s63, s63, s55
  s_lshl_b32 s63, s63, 16
  s_add_u32 s63, s63, s100
  s_add_u32 s63, s63, 49152
  s_add_u32 m0, s6, 40960
  s_nop 0
  buffer_load_dwordx4 v172, s[24:27], s63 offen lds
  v_mov_b32 v200, 0
  v_mov_b32 v201, 0
  v_mov_b32 v202, 0
  v_mov_b32 v203, 0
  v_mov_b32 v204, 0
  v_mov_b32 v205, 0
  v_mov_b32 v206, 0
  v_mov_b32 v207, 0
  v_mov_b32 v208, 0
  v_mov_b32 v209, 0
  v_mov_b32 v210, 0
  v_mov_b32 v211, 0
  v_mov_b32 v212, 0
  v_mov_b32 v213, 0
  v_mov_b32 v214, 0
  v_mov_b32 v215, 0
  v_mov_b32 v216, 0
  v_mov_b32 v217, 0
  v_mov_b32 v218, 0
  v_mov_b32 v219, 0
  v_mov_b32 v220, 0
  v_mov_b32 v221, 0
  v_mov_b32 v222, 0
  v_mov_b32 v223, 0
  v_min_u32 v122, 13, v186
  s_lshr_b32 s62, s56, 1
  s_lshl_b32 s62, s62, 4
  v_add_u32 v122, s62, v122
  v_lshlrev_b32 v122, 7, v122
  v_add_u32 v122, 131072, v122
  s_mul_i32 s62, s60, 112
  s_mul_i32 s63, s54, 28
  s_add_u32 s62, s62, s63
  s_lshl_b32 s62, s62, 10
  s_add_u32 s62, s62, 11534336
  v_lshlrev_b32 v186, 4, v186
  s_waitcnt vmcnt(0)
  v_lshlrev_b32 v192, 16, v224
  v_and_b32 v193, 0xffff0000, v224
  v_lshlrev_b32 v194, 16, v225
  v_and_b32 v195, 0xffff0000, v225
  v_lshlrev_b32 v196, 16, v226
  v_and_b32 v197, 0xffff0000, v226
  v_lshlrev_b32 v198, 16, v227
  v_and_b32 v199, 0xffff0000, v227
  s_cmp_lg_u32 s48, 0
  s_cbranch_scc1 wp_22
  s_mov_b32 s55, 0x40000
poll_23:
  buffer_load_dword v123, v122, s[28:31], 0 offen sc1
  s_waitcnt vmcnt(0)
  v_cmp_ne_u32 vcc, s51, v123
  s_cbranch_vccz pdone_24
  s_sleep 2
  s_sub_u32 s55, s55, 1
  s_cmp_lg_u32 s55, 0
  s_cbranch_scc1 poll_23
  s_mov_b32 s99, 1
pdone_24:
wp_22:
  s_barrier
  s_add_u32 s63, s101, 0
  s_cmp_ge_u32 s63, 7
  s_cselect_b32 s55, 7, 0
  s_sub_u32 s63, s63, s55
  s_lshl_b32 s63, s63, 12
  s_add_u32 s63, s63, s62
  buffer_load_dwordx4 v[72:75], v186, s[28:31], s63 offen offset:0 sc1
  buffer_load_dwordx4 v[76:79], v186, s[28:31], s63 offen offset:1024 sc1
  buffer_load_dwordx4 v[80:83], v186, s[28:31], s63 offen offset:2048 sc1
  buffer_load_dwordx4 v[84:87], v186, s[28:31], s63 offen offset:3072 sc1
  s_add_u32 s63, s101, 1
  s_cmp_ge_u32 s63, 7
  s_cselect_b32 s55, 7, 0
  s_sub_u32 s63, s63, s55
  s_lshl_b32 s63, s63, 12
  s_add_u32 s63, s63, s62
  buffer_load_dwordx4 v[88:91], v186, s[28:31], s63 offen offset:0 sc1
  buffer_load_dwordx4 v[92:95], v186, s[28:31], s63 offen offset:1024 sc1
  ds_read_b64_tr_b16 v[224:225], v184 offset:49152
  ds_read_b64_tr_b16 v[226:227], v184 offset:50176
  ds_read_b64_tr_b16 v[228:229], v185 offset:49152
  ds_read_b64_tr_b16 v[230:231], v185 offset:50176
  ds_read_b64_tr_b16 v[232:233], v184 offset:57344
  ds_read_b64_tr_b16 v[234:235], v184 offset:58368
  ds_read_b64_tr_b16 v[236:237], v185 offset:57344
  ds_read_b64_tr_b16 v[238:239], v185 offset:58368
  v_add_u32 v184, 0x10000, v184
  v_add_u32 v185, 0x10000, v185
  ds_read_b64_tr_b16 v[240:241], v184 offset:0
  ds_read_b64_tr_b16 v[242:243], v184 offset:1024
  ds_read_b64_tr_b16 v[244:245], v185 offset:0
  ds_read_b64_tr_b16 v[246:247], v185 offset:1024
  ds_read_b64_tr_b16 v[248:249], v184 offset:8192
  ds_read_b64_tr_b16 v[250:251], v184 offset:9216
  ds_read_b64_tr_b16 v[252:253], v185 offset:8192
  ds_read_b64_tr_b16 v[254:255], v185 offset:9216
  s_waitcnt vmcnt(5)
  v_mfma_f32_32x32x16_bf16 v[192:207], v[0:3], v[72:75], v[192:207]
  v_mfma_f32_32x32x16_bf16 v[208:223], v[4:7], v[72:75], v[208:223]
  buffer_load_dwordx4 v[96:99], v186, s[28:31], s63 offen offset:2048 sc1
  s_waitcnt vmcnt(5)
  v_mfma_f32_32x32x16_bf16 v[192:207], v[8:11], v[76:79], v[192:207]
  v_mfma_f32_32x32x16_bf16 v[208:223], v[12:15], v[76:79], v[208:223]
  buffer_load_dwordx4 v[100:103], v186, s[28:31], s63 offen offset:3072 sc1
  s_waitcnt vmcnt(5)
  v_mfma_f32_32x32x16_bf16 v[192:207], v[16:19], v[80:83], v[192:207]
  v_mfma_f32_32x32x16_bf16 v[208:223], v[20:23], v[80:83], v[208:223]
  s_add_u32 s63, s101, 2
  s_cmp_ge_u32 s63, 7
  s_cselect_b32 s55, 7, 0
  s_sub_u32 s63, s63, s55
  s_lshl_b32 s63, s63, 12
  s_add_u32 s63, s63, s62
  buffer_load_dwordx4 v[104:107], v186, s[28:31], s63 offen offset:0 sc1
  s_waitcnt vmcnt(5)
  v_mfma_f32_32x32x16_bf16 v[192:207], v[24:27], v[84:87], v[192:207]
  v_mfma_f32_32x32x16_bf16 v[208:223], v[28:31], v[84:87], v[208:223]
  buffer_load_dwordx4 v[108:111], v186, s[28:31], s63 offen offset:1024 sc1
  s_waitcnt vmcnt(5)
  v_mfma_f32_32x32x16_bf16 v[192:207], v[32:35], v[88:91], v[192:207]
  v_mfma_f32_32x32x16_bf16 v[208:223], v[36:39], v[88:91], v[208:223]
  buffer_load_dwordx4 v[112:115], v186, s[28:31], s63 offen offset:2048 sc1
  s_waitcnt vmcnt(5)
  v_mfma_f32_32x32x16_bf16 v[192:207], v[40:43], v[92:95], v[192:207]
  v_mfma_f32_32x32x16_bf16 v[208:223], v[44:47], v[92:95], v[208:223]
  buffer_load_dwordx4 v[116:119], v186, s[28:31], s63 offen offset:3072 sc1
  s_waitcnt vmcnt(5)
  v_mfma_f32_32x32x16_bf16 v[192:207], v[48:51], v[96:99], v[192:207]
  v_mfma_f32_32x32x16_bf16 v[208:223], v[52:55], v[96:99], v[208:223]
  s_add_u32 s63, s101, 3
  s_cmp_ge_u32 s63, 7
  s_cselect_b32 s55, 7, 0
  s_sub_u32 s63, s63, s55
  s_lshl_b32 s63, s63, 12
  s_add_u32 s63, s63, s62
  buffer_load_dwordx4 v[120:123], v186, s[28:31], s63 offen offset:0 sc1
  s_waitcnt vmcnt(5)
  v_mfma_f32_32x32x16_bf16 v[192:207], v[56:59], v[100:103], v[192:207]
  v_mfma_f32_32x32x16_bf16 v[208:223], v[60:63], v[100:103], v[208:223]
  buffer_load_dwordx4 v[124:127], v186, s[28:31], s63 offen offset:1024 sc1
  s_waitcnt vmcnt(5)
  v_mfma_f32_32x32x16_bf16 v[192:207], v[64:67], v[104:107], v[192:207]
  v_mfma_f32_32x32x16_bf16 v[208:223], v[68:71], v[104:107], v[208:223]
  buffer_load_dwordx4 v[128:131], v186, s[28:31], s63 offen offset:2048 sc1
  s_waitcnt vmcnt(5) lgkmcnt(12)
  v_mfma_f32_32x32x16_bf16 v[192:207], v[224:227], v[108:111], v[192:207]
  v_mfma_f32_32x32x16_bf16 v[208:223], v[228:231], v[108:111], v[208:223]
  buffer_load_dwordx4 v[132:135], v186, s[28:31], s63 offen offset:3072 sc1
  ds_read_b64_tr_b16 v[224:225], v184 offset:16384
  ds_read_b64_tr_b16 v[226:227], v184 offset:17408
  ds_read_b64_tr_b16 v[228:229], v185 offset:16384
  ds_read_b64_tr_b16 v[230:231], v185 offset:17408
  s_waitcnt vmcnt(5) lgkmcnt(12)
  v_mfma_f32_32x32x16_bf16 v[192:207], v[232:235], v[112:115], v[192:207]
  v_mfma_f32_32x32x16_bf16 v[208:223], v[236:239], v[112:115], v[208:223]
  s_add_u32 s63, s101, 4
  s_cmp_ge_u32 s63, 7
  s_cselect_b32 s55, 7, 0
  s_sub_u32 s63, s63, s55
  s_lshl_b32 s63, s63, 12
  s_add_u32 s63, s63, s62
  buffer_load_dwordx4 v[136:139], v186, s[28:31], s63 offen offset:0 sc1
  ds_read_b64_tr_b16 v[232:233], v184 offset:24576
  ds_read_b64_tr_b16 v[234:235], v184 offset:25600
  ds_read_b64_tr_b16 v[236:237], v185 offset:24576
  ds_read_b64_tr_b16 v[238:239], v185 offset:25600
  s_waitcnt vmcnt(5) lgkmcnt(12)
  v_mfma_f32_32x32x16_bf16 v[192:207], v[240:243], v[116:119], v[192:207]
  v_mfma_f32_32x32x16_bf16 v[208:223], v[244:247], v[116:119], v[208:223]
  buffer_load_dwordx4 v[140:143], v186, s[28:31], s63 offen offset:1024 sc1
  ds_read_b64_tr_b16 v[240:241], v184 offset:32768
  ds_read_b64_tr_b16 v[242:243], v184 offset:33792
  ds_read_b64_tr_b16 v[244:245], v185 offset:32768
  ds_read_b64_tr_b16 v[246:247], v185 offset:33792
  s_waitcnt vmcnt(5) lgkmcnt(12)
  v_mfma_f32_32x32x16_bf16 v[192:207], v[248:251], v[120:123], v[192:207]
  v_mfma_f32_32x32x16_bf16 v[208:223], v[252:255], v[120:123], v[208:223]
  buffer_load_dwordx4 v[144:147], v186, s[28:31], s63 offen offset:2048 sc1
  ds_read_b64_tr_b16 v[248:249], v184 offset:40960
  ds_read_b64_tr_b16 v[250:251], v184 offset:41984
  ds_read_b64_tr_b16 v[252:253], v185 offset:40960
  ds_read_b64_tr_b16 v[254:255], v185 offset:41984
  s_waitcnt vmcnt(5) lgkmcnt(12)
  v_mfma_f32_32x32x16_bf16 v[192:207], v[224:227], v[124:127], v[192:207]
  v_mfma_f32_32x32x16_bf16 v[208:223], v[228:231], v[124:127], v[208:223]
  buffer_load_dwordx4 v[148:151], v186, s[28:31], s63 offen offset:3072 sc1
  ds_read_b64_tr_b16 v[224:225], v184 offset:49152
  ds_read_b64_tr_b16 v[226:227], v184 offset:50176
  ds_read_b64_tr_b16 v[228:229], v185 offset:49152
  ds_read_b64_tr_b16 v[230:231], v185 offset:50176
  s_waitcnt vmcnt(5) lgkmcnt(12)
  v_mfma_f32_32x32x16_bf16 v[192:207], v[232:235], v[128:131], v[192:207]
  v_mfma_f32_32x32x16_bf16 v[208:223], v[236:239], v[128:131], v[208:223]
  s_add_u32 s63, s101, 5
  s_cmp_ge_u32 s63, 7
  s_cselect_b32 s55, 7, 0
  s_sub_u32 s63, s63, s55
  s_lshl_b32 s63, s63, 12
  s_add_u32 s63, s63, s62
  buffer_load_dwordx4 v[152:155], v186, s[28:31], s63 offen offset:0 sc1
  ds_read_b64_tr_b16 v[232:233], v184 offset:57344
  ds_read_b64_tr_b16 v[234:235], v184 offset:58368
  ds_read_b64_tr_b16 v[236:237], v185 offset:57344
  ds_read_b64_tr_b16 v[238:239], v185 offset:58368
  s_waitcnt vmcnt(5) lgkmcnt(12)
  v_mfma_f32_32x32x16_bf16 v[192:207], v[240:243], v[132:135], v[192:207]
  v_mfma_f32_32x32x16_bf16 v[208:223], v[244:247], v[132:135], v[208:223]
  buffer_load_dwordx4 v[156:159], v186, s[28:31], s63 offen offset:1024 sc1
  v_add_u32 v184, 0x10000, v184
  v_add_u32 v185, 0x10000, v185
  ds_read_b64_tr_b16 v[240:241], v184 offset:0
  ds_read_b64_tr_b16 v[242:243], v184 offset:1024
  ds_read_b64_tr_b16 v[244:245], v185 offset:0
  ds_read_b64_tr_b16 v[246:247], v185 offset:1024
  s_waitcnt vmcnt(5) lgkmcnt(12)
  v_mfma_f32_32x32x16_bf16 v[192:207], v[248:251], v[136:139], v[192:207]
  v_mfma_f32_32x32x16_bf16 v[208:223], v[252:255], v[136:139], v[208:223]
  buffer_load_dwordx4 v[160:163], v186, s[28:31], s63 offen offset:2048 sc1
  ds_read_b64_tr_b16 v[248:249], v184 offset:8192
  ds_read_b64_tr_b16 v[250:251], v184 offset:9216
  ds_read_b64_tr_b16 v[252:253], v185 offset:8192
  ds_read_b64_tr_b16 v[254:255], v185 offset:9216
  s_waitcnt vmcnt(5) lgkmcnt(12)
  v_mfma_f32_32x32x16_bf16 v[192:207], v[224:227], v[140:143], v[192:207]
  v_mfma_f32_32x32x16_bf16 v[208:223], v[228:231], v[140:143], v[208:223]
  buffer_load_dwordx4 v[164:167], v186, s[28:31], s63 offen offset:3072 sc1
  ds_read_b64_tr_b16 v[224:225], v184 offset:16384
  ds_read_b64_tr_b16 v[226:227], v184 offset:17408
  ds_read_b64_tr_b16 v[228:229], v185 offset:16384
  ds_read_b64_tr_b16 v[230:231], v185 offset:17408
  s_waitcnt vmcnt(5) lgkmcnt(12)
  v_mfma_f32_32x32x16_bf16 v[192:207], v[232:235], v[144:147], v[192:207]
  v_mfma_f32_32x32x16_bf16 v[208:223], v[236:239], v[144:147], v[208:223]
  s_add_u32 s63, s101, 6
  s_cmp_ge_u32 s63, 7
  s_cselect_b32 s55, 7, 0
  s_sub_u32 s63, s63, s55
  s_lshl_b32 s63, s63, 12
  s_add_u32 s63, s63, s62
  buffer_load_dwordx4 v[168:171], v186, s[28:31], s63 offen offset:0 sc1
  v_add_u32 v184, 0xfffe0000, v184
  v_add_u32 v185, 0xfffe0000, v185
  ds_read_b64_tr_b16 v[232:233], v184 offset:0
  ds_read_b64_tr_b16 v[234:235], v184 offset:1024
  ds_read_b64_tr_b16 v[236:237], v185 offset:0
  ds_read_b64_tr_b16 v[238:239], v185 offset:1024
  s_waitcnt vmcnt(5) lgkmcnt(12)
  v_mfma_f32_32x32x16_bf16 v[192:207], v[240:243], v[148:151], v[192:207]
  v_mfma_f32_32x32x16_bf16 v[208:223], v[244:247], v[148:151], v[208:223]
  buffer_load_dwordx4 v[172:175], v186, s[28:31], s63 offen offset:1024 sc1
  ds_read_b64_tr_b16 v[240:241], v184 offset:8192
  ds_read_b64_tr_b16 v[242:243], v184 offset:9216
  ds_read_b64_tr_b16 v[244:245], v185 offset:8192
  ds_read_b64_tr_b16 v[246:247], v185 offset:9216
  s_waitcnt vmcnt(5) lgkmcnt(12)
  v_mfma_f32_32x32x16_bf16 v[192:207], v[248:251], v[152:155], v[192:207]
  v_mfma_f32_32x32x16_bf16 v[208:223], v[252:255], v[152:155], v[208:223]
  buffer_load_dwordx4 v[176:179], v186, s[28:31], s63 offen offset:2048 sc1
  ds_read_b64_tr_b16 v[248:249], v184 offset:16384
  ds_read_b64_tr_b16 v[250:251], v184 offset:17408
  ds_read_b64_tr_b16 v[252:253], v185 offset:16384
  ds_read_b64_tr_b16 v[254:255], v185 offset:17408
  s_waitcnt vmcnt(5) lgkmcnt(12)
  v_mfma_f32_32x32x16_bf16 v[192:207], v[224:227], v[156:159], v[192:207]
  v_mfma_f32_32x32x16_bf16 v[208:223], v[228:231], v[156:159], v[208:223]
  buffer_load_dwordx4 v[180:183], v186, s[28:31], s63 offen offset:3072 sc1
  ds_read_b64_tr_b16 v[224:225], v184 offset:24576
  ds_read_b64_tr_b16 v[226:227], v184 offset:25600
  ds_read_b64_tr_b16 v[228:229], v185 offset:24576
  ds_read_b64_tr_b16 v[230:231], v185 offset:25600
  s_waitcnt vmcnt(5) lgkmcnt(12)
  v_mfma_f32_32x32x16_bf16 v[192:207], v[232:235], v[160:163], v[192:207]
  v_mfma_f32_32x32x16_bf16 v[208:223], v[236:239], v[160:163], v[208:223]
  ds_read_b64_tr_b16 v[232:233], v184 offset:32768
  ds_read_b64_tr_b16 v[234:235], v184 offset:33792
  ds_read_b64_tr_b16 v[236:237], v185 offset:32768
  ds_read_b64_tr_b16 v[238:239], v185 offset:33792
  s_waitcnt vmcnt(4) lgkmcnt(12)
  v_mfma_f32_32x32x16_bf16 v[192:207], v[240:243], v[164:167], v[192:207]
  v_mfma_f32_32x32x16_bf16 v[208:223], v[244:247], v[164:167], v[208:223]
  ds_read_b64_tr_b16 v[240:241], v184 offset:40960
  ds_read_b64_tr_b16 v[242:243], v184 offset:41984
  ds_read_b64_tr_b16 v[244:245], v185 offset:40960
  ds_read_b64_tr_b16 v[246:247], v185 offset:41984
  s_waitcnt vmcnt(3) lgkmcnt(12)
  v_mfma_f32_32x32x16_bf16 v[192:207], v[248:251], v[168:171], v[192:207]
  v_mfma_f32_32x32x16_bf16 v[208:223], v[252:255], v[168:171], v[208:223]
  s_barrier
  s_waitcnt vmcnt(2) lgkmcnt(8)
  v_mfma_f32_32x32x16_bf16 v[192:207], v[224:227], v[172:175], v[192:207]
  v_mfma_f32_32x32x16_bf16 v[208:223], v[228:231], v[172:175], v[208:223]
  s_waitcnt vmcnt(1) lgkmcnt(4)
  v_mfma_f32_32x32x16_bf16 v[192:207], v[232:235], v[176:179], v[192:207]
  v_mfma_f32_32x32x16_bf16 v[208:223], v[236:239], v[176:179], v[208:223]
  s_waitcnt vmcnt(0) lgkmcnt(0)
  v_mfma_f32_32x32x16_bf16 v[192:207], v[240:243], v[180:183], v[192:207]
  v_mfma_f32_32x32x16_bf16 v[208:223], v[244:247], v[180:183], v[208:223]
  v_lshrrev_b32 v186, 4, v186
  s_nop 0
  v_lshlrev_b32 v24, 4, v186
  s_mul_i32 s62, s53, 24576
  s_add_u32 s62, s62, 49152
  s_add_u32 s63, s54, 1
  s_and_b32 s63, s63, 3
  s_mul_i32 s63, s63, 6144
  s_add_u32 s63, s63, s62
  v_add_u32 v25, s63, v24
  s_nop 5
  ds_write_b128 v25, v[200:203] offset:0
  ds_write_b128 v25, v[204:207] offset:1024
  s_add_u32 s63, s54, 2
  s_and_b32 s63, s63, 3
  s_mul_i32 s63, s63, 6144
  s_add_u32 s63, s63, s62
  v_add_u32 v25, s63, v24
  ds_write_b128 v25, v[208:211] offset:2048
  ds_write_b128 v25, v[212:215] offset:3072
  s_add_u32 s63, s54, 3
  s_and_b32 s63, s63, 3
  s_mul_i32 s63, s63, 6144
  s_add_u32 s63, s63, s62
  v_add_u32 v25, s63, v24
  ds_write_b128 v25, v[216:219] offset:4096
  ds_write_b128 v25, v[220:223] offset:5120
  s_mul_i32 s63, s54, 6144
  s_add_u32 s63, s63, s62
  v_add_u32 v25, s63, v24
  s_waitcnt lgkmcnt(0)
  s_barrier
  ds_read_b128 v[0:3], v25 offset:0
  ds_read_b128 v[4:7], v25 offset:1024
  ds_read_b128 v[8:11], v25 offset:2048
  ds_read_b128 v[12:15], v25 offset:3072
  ds_read_b128 v[16:19], v25 offset:4096
  ds_read_b128 v[20:23], v25 offset:5120
  s_waitcnt lgkmcnt(4)
  v_pk_add_f32 v[192:193], v[192:193], v[0:1]
  v_pk_add_f32 v[194:195], v[194:195], v[2:3]
  v_pk_add_f32 v[196:197], v[196:197], v[4:5]
  v_pk_add_f32 v[198:199], v[198:199], v[6:7]
  s_waitcnt lgkmcnt(2)
  v_pk_add_f32 v[192:193], v[192:193], v[8:9]
  v_pk_add_f32 v[194:195], v[194:195], v[10:11]
  v_pk_add_f32 v[196:197], v[196:197], v[12:13]
  v_pk_add_f32 v[198:199], v[198:199], v[14:15]
  s_waitcnt lgkmcnt(0)
  v_pk_add_f32 v[192:193], v[192:193], v[16:17]
  v_pk_add_f32 v[194:195], v[194:195], v[18:19]
  v_pk_add_f32 v[196:197], v[196:197], v[20:21]
  v_pk_add_f32 v[198:199], v[198:199], v[22:23]
  v_lshlrev_b32 v0, 16, v188
  v_and_b32 v1, 0xffff0000, v188
  v_lshlrev_b32 v2, 16, v189
  v_and_b32 v3, 0xffff0000, v189
  v_lshlrev_b32 v4, 16, v190
  v_and_b32 v5, 0xffff0000, v190
  v_lshlrev_b32 v6, 16, v191
  v_and_b32 v7, 0xffff0000, v191
  v_pk_add_f32 v[192:193], v[192:193], v[0:1]
  v_pk_add_f32 v[194:195], v[194:195], v[2:3]
  v_pk_add_f32 v[196:197], v[196:197], v[4:5]
  v_pk_add_f32 v[198:199], v[198:199], v[6:7]
  v_cvt_pk_bf16_f32 v8, v192, v193
  v_cvt_pk_bf16_f32 v9, v194, v195
  v_cvt_pk_bf16_f32 v10, v196, v197
  v_cvt_pk_bf16_f32 v11, v198, v199
  v_and_b32 v24, 31, v186
  s_lshl_b32 s62, s60, 5
  v_add_u32 v24, s62, v24
  v_lshlrev_b32 v24, 10, v24
  v_lshrrev_b32 v25, 5, v186
  v_lshl_add_u32 v24, v25, 4, v24
  v_permlane32_swap_b32 v8, v10
  v_permlane32_swap_b32 v9, v11
  s_nop 1
  buffer_store_dwordx4 v[8:11], v24, s[32:35], s3 offen
L_end:
  s_endpgm
.section .rodata,"a"
.p2align 6
.amdhsa_kernel sequential_preLN__sliding_block__dense_activation_squared_relu__prompt_kernel
  .amdhsa_next_free_vgpr 256
  .amdhsa_next_free_sgpr 102
  .amdhsa_accum_offset 256
  .amdhsa_group_segment_fixed_size 0
  .amdhsa_kernarg_size 88
  .amdhsa_user_sgpr_count 2
  .amdhsa_user_sgpr_kernarg_segment_ptr 1
  .amdhsa_system_sgpr_workgroup_id_x 1
.end_amdhsa_kernel
```
